```python
import torch

def _softmax(x, axis=-1):
    return torch.softmax(x, dim=axis)
def _gelu(x):
    return torch.nn.functional.gelu(x, approximate="tanh")
def _silu(x):
    return torch.nn.functional.silu(x)
def _sigmoid(x):
    return torch.sigmoid(x)
def _layernorm(x, axis=-1, eps=1e-5):
    m = x.mean(dim=axis, keepdim=True)
    v = x.var(dim=axis, keepdim=True, unbiased=False)
    return (x - m) / torch.sqrt(v + eps)
def _scatter_add(tgt, idx, src, axis=0):
    return tgt.clone().index_add_(axis, idx, src)
def _segment_sum(src, seg, n):
    out = torch.zeros((n,) + src.shape[1:], dtype=src.dtype)
    return out.index_add_(0, seg, src)
def _pad(x, pw):
    flat = tuple(v for pair in reversed(pw) for v in pair)
    return torch.nn.functional.pad(x, flat)

kernel_name = 'sequential_preLN__gqa_block_cached__glu_gated_swiglu__decode'

def setup_inputs():

    _w = (lambda a: (lambda t: t.to(torch.bfloat16) if t.is_floating_point() else t)(torch.as_tensor(a)))
    def _A_setup():
        B, Sq, D = 2, 1, 576
        Hq, Hkv, Sk, Dh = 32, 16, 32768, 128
        assert Hq % Hkv == 0, (Hq, Hkv)
        return {
            "x": _w((lambda *s: torch.randn(*s, dtype=torch.bfloat16) * 0.05)(B, Sq, D)),
            "k_cache": _w((lambda *s: torch.randn(*s, dtype=torch.bfloat16) * 3.2)(B, Hkv, Sk, Dh)),
            "v_cache": _w((lambda *s: torch.randn(*s, dtype=torch.bfloat16) * 1.6)(B, Hkv, Sk, Dh)),
            "wq": _w((lambda *s: torch.randn(*s, dtype=torch.bfloat16) * 3.2)(D, Hq * Dh) * (D ** -0.5)),
            "wo": _w((lambda *s: torch.randn(*s, dtype=torch.bfloat16) * 1.6)(Hq * Dh, D) * ((Hq * Dh) ** -0.5)),
        }
    _A_in = _A_setup()

    def _B_setup():
        B, S, D, F = 2, 1, 576, 4608
        return {
            "x": _w((lambda *s: torch.randn(*s, dtype=torch.bfloat16) * 0.05)(B, S, D)),
            "w1": _w((lambda *s: torch.randn(*s, dtype=torch.bfloat16) * 1.6)(D, F) * (2.0 / D) ** 0.5),
            "w3": _w((lambda *s: torch.randn(*s, dtype=torch.bfloat16) * 1.6)(D, F) * (2.0 / D) ** 0.5),
            "w2": _w((lambda *s: torch.randn(*s, dtype=torch.bfloat16) * 1.6)(F, D) * (2.0 / F) ** 0.5),
        }
    _B_in = _B_setup()

    return {
        "A_x": _A_in["x"],
        "A_k_cache": _A_in["k_cache"],
        "A_v_cache": _A_in["v_cache"],
        "A_wq": _A_in["wq"],
        "A_wo": _A_in["wo"],
        "B_x": _B_in["x"],
        "B_w1": _B_in["w1"],
        "B_w3": _B_in["w3"],
        "B_w2": _B_in["w2"],
    }

def reference(A_x, A_k_cache, A_v_cache, A_wq, A_wo, B_x, B_w1, B_w3, B_w2):
    def _A_ref(x, k_cache, v_cache, wq, wo):
        B, Sq, D = x.shape
        Hq, Dh = 32, 128
        Hkv = k_cache.shape[1]
        rep = Hq // Hkv
        q = (lambda x, *d: x.permute(*d))((x @ wq).reshape(B, Sq, Hq, Dh), 0, 2, 1, 3)
        k = (lambda x, n, axis: torch.repeat_interleave(x, n, dim=axis))(k_cache, rep, axis=1)
        v = (lambda x, n, axis: torch.repeat_interleave(x, n, dim=axis))(v_cache, rep, axis=1)
        scores = torch.einsum("bhqd,bhkd->bhqk", q, k) * (Dh ** -0.5)
        p = _softmax(scores, axis=-1)
        o = torch.einsum("bhqk,bhkd->bhqd", p, v)
        return (lambda x, *d: x.permute(*d))(o, 0, 2, 1, 3).reshape(B, Sq, Hq * Dh) @ wo

    def _B_ref(x, w1, w3, w2):
        gate = torch.einsum("bsd,df->bsf", x, w1)
        up = torch.einsum("bsd,df->bsf", x, w3)
        h = _silu(gate) * up
        out = torch.einsum("bsf,fd->bsd", h, w2)
        return out

    x = A_x
    h = x + _A_ref(_layernorm(x, axis=-1), A_k_cache, A_v_cache, A_wq, A_wo)
    h2 = h + _B_ref(_layernorm(h, axis=-1), B_w1, B_w3, B_w2)
    return h2
```

```asm
; @launch grid=(256,1,1) block=(256,1,1) lds=163840
.amdgcn_target "amdgcn-amd-amdhsa--gfx950"
.text
.globl sequential_preLN__gqa_block_cached__glu_gated_swiglu__decode_kernel
.p2align 8
.type sequential_preLN__gqa_block_cached__glu_gated_swiglu__decode_kernel,@function
sequential_preLN__gqa_block_cached__glu_gated_swiglu__decode_kernel:
    s_cmp_ge_u32 s2, 256
    s_cbranch_scc1 L_end
    s_load_dwordx16 s[4:19], s[0:1], 0
    s_load_dwordx8 s[20:27], s[0:1], 64
    s_getpc_b64 s[82:83]
L_pc:
    s_lshl_b32 s65, s2, 3
    s_add_u32 s65, s65, L_table-L_pc
    s_load_dwordx2 s[58:59], s[82:83], s65
    v_and_b32 v1, 63, v0
    v_lshrrev_b32 v41, 6, v0
    s_nop 0
    v_readfirstlane_b32 s56, v41
    s_mov_b32 s76, 0xffff0000
    s_mov_b32 s77, 0x3db504f3
    s_mov_b32 s78, 0x3fb8aa3b
    s_mov_b32 s79, 0xff
    s_mov_b32 s73, 2000000
    s_lshr_b32 s80, s2, 3
    s_and_b32 s81, s2, 7
    v_lshrrev_b32 v58, 4, v1
    v_lshlrev_b32 v3, 4, v1
    v_lshrrev_b32 v41, 5, v1
    v_mul_u32_u24 v41, 1152, v41
    v_and_b32 v42, 31, v1
    v_mad_u32_u24 v128, v42, 12, v41
    v_lshrrev_b32 v41, 3, v1
    v_and_b32 v42, 7, v1
    v_lshlrev_b32 v42, 4, v42
    v_lshl_add_u32 v129, v41, 13, v42
    v_bfe_u32 v41, v1, 2, 2
    v_lshlrev_b32 v41, 8, v41
    v_lshl_add_u32 v41, v58, 6, v41
    v_and_b32 v42, 3, v1
    v_lshl_add_u32 v2, v42, 4, v41
    s_and_b32 s71, s2, 63
    s_lshr_b32 s72, s2, 6
    s_mul_i32 s66, s72, 160
    s_cmp_eq_u32 s72, 3
    s_cselect_b32 s66, 448, s66
    s_lshl_b32 s67, s56, 3
    s_add_u32 s67, s67, s66
    s_lshl_b32 s67, s67, 13
    s_lshl_b32 s68, s71, 7
    s_add_u32 s67, s67, s68
    s_lshl_b32 s69, s56, 10
    s_add_u32 s69, s69, 73728
    s_lshl_b32 s65, s80, 23
    s_waitcnt lgkmcnt(0)
    s_mov_b32 s48, s4
    s_mov_b32 s49, s5
    s_mov_b32 s50, 2304
    s_mov_b32 s51, 0x20000
    s_mov_b32 s52, s10
    s_mov_b32 s53, s11
    s_mov_b32 s54, 4718592
    s_mov_b32 s55, 0x20000
    s_load_dword s89, s[26:27], 0
    buffer_load_dwordx3 v[132:134], v128, s[48:51], 0 offen offset:0
    buffer_load_dwordx3 v[136:138], v128, s[48:51], 0 offen offset:384
    buffer_load_dwordx3 v[140:142], v128, s[48:51], 0 offen offset:768
    s_add_u32 m0, s69, 0
    s_nop 0
    buffer_load_dwordx4 v129, s[52:55], s67 offen nt lds
    s_add_u32 s67, s67, 262144
    s_add_u32 m0, s69, 4096
    s_nop 0
    buffer_load_dwordx4 v129, s[52:55], s67 offen nt lds
    s_add_u32 s67, s67, 262144
    s_add_u32 m0, s69, 8192
    s_nop 0
    buffer_load_dwordx4 v129, s[52:55], s67 offen nt lds
    s_add_u32 s67, s67, 262144
    s_add_u32 m0, s69, 12288
    s_nop 0
    buffer_load_dwordx4 v129, s[52:55], s67 offen nt lds
    s_add_u32 s67, s67, 262144
    s_cmp_lt_u32 s72, 2
    s_cselect_b32 s67, s67, 0x80000000
    s_add_u32 m0, s69, 16384
    s_nop 0
    buffer_load_dwordx4 v129, s[52:55], s67 offen nt lds
    s_add_u32 s28, s6, s65
    s_addc_u32 s29, s7, 0
    s_mov_b32 s30, 8388608
    s_mov_b32 s31, 0x20000
    s_add_u32 s32, s8, s65
    s_addc_u32 s33, s9, 0
    s_mov_b32 s34, 8388608
    s_mov_b32 s35, 0x20000
    s_mov_b32 s36, s26
    s_mov_b32 s37, s27
    s_mov_b32 s38, 2097152
    s_mov_b32 s39, 0x20000
    s_lshr_b32 s65, s2, 2
    s_mul_i32 s65, s65, 256
    s_add_u32 s65, s65, 933888
    s_and_b32 s66, s2, 0x83
    s_or_b32 s66, s66, s56
    s_cmp_eq_u32 s66, 0
    s_cselect_b32 s65, s65, 0x80000000
    v_mov_b32 v41, 0
    v_cmp_eq_u32 vcc, 0, v1
    v_mov_b32 v42, 0x40000000
    s_nop 0
    v_cndmask_b32 v42, v42, v41, vcc
    buffer_store_dword v41, v42, s[36:39], s65 offen sc1
    s_mul_i32 s66, s72, 160
    s_cmp_eq_u32 s72, 3
    s_cselect_b32 s66, 448, s66
    s_mul_i32 s65, s80, 256
    s_add_u32 s65, s65, 933888
    s_add_u32 s24, s26, s65
    s_addc_u32 s25, s27, 0
    s_and_b32 s65, s58, 0x3ff
    s_add_u32 s65, s65, 48
    v_add_u32 v41, s65, v1
    v_cmp_gt_u32 vcc, 3, v1
    s_nop 1
    v_cndmask_b32 v41, -1, v41, vcc
    v_lshlrev_b32 v42, 2, v1
    v_add_u32 v42, 163136, v42
    v_mov_b32 v43, -1
    ds_write_b32 v42, v41
    ds_write_b32 v42, v43 offset:256
    ds_write_b32 v42, v43 offset:448
    s_and_b32 s60, s58, 0x3ff
    s_lshl_b32 s60, s60, 14
    s_lshl_b32 s65, s56, 12
    s_add_u32 s60, s60, s65
    s_bfe_u32 s63, s58, 0x6000a
    s_bfe_u32 s64, s58, 0x40010
    s_lshr_b32 s70, s58, 24
    buffer_load_dwordx4 v[64:67], v2, s[28:31], s60 offen offset:0 nt
    buffer_load_dwordx4 v[68:71], v2, s[28:31], s60 offen offset:1024 nt
    buffer_load_dwordx4 v[72:75], v2, s[28:31], s60 offen offset:2048 nt
    buffer_load_dwordx4 v[76:79], v2, s[28:31], s60 offen offset:3072 nt
    s_add_u32 s62, s60, 16384
    buffer_load_dwordx4 v[80:83], v2, s[28:31], s62 offen offset:0 nt
    buffer_load_dwordx4 v[84:87], v2, s[28:31], s62 offen offset:1024 nt
    buffer_load_dwordx4 v[88:91], v2, s[28:31], s62 offen offset:2048 nt
    buffer_load_dwordx4 v[92:95], v2, s[28:31], s62 offen offset:3072 nt
    s_lshr_b32 s65, s2, 3
    s_lshl_b32 s65, s65, 2
    s_add_u32 s65, s65, s56
    s_lshl_b32 s65, s65, 10
    s_min_u32 s65, s65, L_table-L_pc-1024
    v_add_u32 v41, s65, v3
    global_load_dwordx4 v[244:247], v41, s[82:83]
    v_bfe_u32 v41, v1, 3, 1
    v_bfe_u32 v42, v1, 1, 1
    v_lshl_add_u32 v41, v41, 1, v42
    v_and_b32 v42, 1, v1
    v_cmp_eq_u32 vcc, 1, v42
    v_mov_b32 v43, 0xffff
    v_mov_b32 v44, s76
    v_cndmask_b32 v43, v43, v44, vcc
    v_cmp_eq_u32 vcc, 0, v41
    s_nop 1
    v_cndmask_b32 v4, 0, v43, vcc
    v_cmp_eq_u32 vcc, 1, v41
    s_nop 1
    v_cndmask_b32 v5, 0, v43, vcc
    v_cmp_eq_u32 vcc, 2, v41
    s_nop 1
    v_cndmask_b32 v6, 0, v43, vcc
    v_cmp_eq_u32 vcc, 3, v41
    s_nop 1
    v_cndmask_b32 v7, 0, v43, vcc
    s_waitcnt vmcnt(15)
    v_lshlrev_b32 v144, 16, v132
    v_and_b32 v145, s76, v132
    v_lshlrev_b32 v146, 16, v133
    v_and_b32 v147, s76, v133
    v_lshlrev_b32 v148, 16, v134
    v_and_b32 v149, s76, v134
    v_lshlrev_b32 v150, 16, v136
    v_and_b32 v151, s76, v136
    v_lshlrev_b32 v152, 16, v137
    v_and_b32 v153, s76, v137
    v_lshlrev_b32 v154, 16, v138
    v_and_b32 v155, s76, v138
    v_lshlrev_b32 v156, 16, v140
    v_and_b32 v157, s76, v140
    v_lshlrev_b32 v158, 16, v141
    v_and_b32 v159, s76, v141
    v_lshlrev_b32 v160, 16, v142
    v_and_b32 v161, s76, v142
    v_add_f32 v164, v144, v145
    v_add_f32 v165, v146, v147
    v_add_f32 v164, v164, v148
    v_add_f32 v165, v165, v149
    v_add_f32 v164, v164, v150
    v_add_f32 v165, v165, v151
    v_add_f32 v164, v164, v152
    v_add_f32 v165, v165, v153
    v_add_f32 v164, v164, v154
    v_add_f32 v165, v165, v155
    v_add_f32 v164, v164, v156
    v_add_f32 v165, v165, v157
    v_add_f32 v164, v164, v158
    v_add_f32 v165, v165, v159
    v_add_f32 v164, v164, v160
    v_add_f32 v165, v165, v161
    v_add_f32 v164, v164, v165
    s_nop 1
    v_add_f32_dpp v164, v164, v164 quad_perm:[1,0,3,2] row_mask:0xf bank_mask:0xf
    s_nop 1
    v_add_f32_dpp v164, v164, v164 quad_perm:[2,3,0,1] row_mask:0xf bank_mask:0xf
    s_nop 1
    v_add_f32_dpp v164, v164, v164 row_half_mirror row_mask:0xf bank_mask:0xf
    s_nop 1
    v_add_f32_dpp v164, v164, v164 row_mirror row_mask:0xf bank_mask:0xf
    v_mov_b32 v166, v164
    s_nop 1
    v_permlane16_swap_b32 v164, v166
    v_add_f32 v164, v164, v166
    v_mul_f32 v164, 0x3ae38e39, v164
    v_sub_f32 v166, v144, v164
    v_mul_f32 v165, v166, v166
    v_sub_f32 v166, v145, v164
    v_mul_f32 v167, v166, v166
    v_sub_f32 v166, v146, v164
    v_fmac_f32 v165, v166, v166
    v_sub_f32 v166, v147, v164
    v_fmac_f32 v167, v166, v166
    v_sub_f32 v166, v148, v164
    v_fmac_f32 v165, v166, v166
    v_sub_f32 v166, v149, v164
    v_fmac_f32 v167, v166, v166
    v_sub_f32 v166, v150, v164
    v_fmac_f32 v165, v166, v166
    v_sub_f32 v166, v151, v164
    v_fmac_f32 v167, v166, v166
    v_sub_f32 v166, v152, v164
    v_fmac_f32 v165, v166, v166
    v_sub_f32 v166, v153, v164
    v_fmac_f32 v167, v166, v166
    v_sub_f32 v166, v154, v164
    v_fmac_f32 v165, v166, v166
    v_sub_f32 v166, v155, v164
    v_fmac_f32 v167, v166, v166
    v_sub_f32 v166, v156, v164
    v_fmac_f32 v165, v166, v166
    v_sub_f32 v166, v157, v164
    v_fmac_f32 v167, v166, v166
    v_sub_f32 v166, v158, v164
    v_fmac_f32 v165, v166, v166
    v_sub_f32 v166, v159, v164
    v_fmac_f32 v167, v166, v166
    v_sub_f32 v166, v160, v164
    v_fmac_f32 v165, v166, v166
    v_sub_f32 v166, v161, v164
    v_fmac_f32 v167, v166, v166
    v_add_f32 v165, v165, v167
    s_nop 1
    v_add_f32_dpp v165, v165, v165 quad_perm:[1,0,3,2] row_mask:0xf bank_mask:0xf
    s_nop 1
    v_add_f32_dpp v165, v165, v165 quad_perm:[2,3,0,1] row_mask:0xf bank_mask:0xf
    s_nop 1
    v_add_f32_dpp v165, v165, v165 row_half_mirror row_mask:0xf bank_mask:0xf
    s_nop 1
    v_add_f32_dpp v165, v165, v165 row_mirror row_mask:0xf bank_mask:0xf
    v_mov_b32 v166, v165
    s_nop 1
    v_permlane16_swap_b32 v165, v166
    v_add_f32 v165, v165, v166
    v_mul_f32 v165, 0x3ae38e39, v165
    v_cvt_pk_bf16_f32 v166, v164, v165
    v_lshlrev_b32 v164, 16, v166
    v_and_b32 v165, s76, v166
    v_add_f32 v165, 0x3727c5ac, v165
    v_cvt_pk_bf16_f32 v165, v165, v165
    v_and_b32 v165, s76, v165
    v_sqrt_f32 v165, v165
    s_nop 0
    v_cvt_pk_bf16_f32 v165, v165, v165
    v_and_b32 v165, s76, v165
    v_rcp_f32 v165, v165
    v_sub_f32 v144, v144, v164
    v_sub_f32 v145, v145, v164
    v_sub_f32 v146, v146, v164
    v_sub_f32 v147, v147, v164
    v_sub_f32 v148, v148, v164
    v_sub_f32 v149, v149, v164
    v_sub_f32 v150, v150, v164
    v_sub_f32 v151, v151, v164
    v_sub_f32 v152, v152, v164
    v_sub_f32 v153, v153, v164
    v_sub_f32 v154, v154, v164
    v_sub_f32 v155, v155, v164
    v_sub_f32 v156, v156, v164
    v_sub_f32 v157, v157, v164
    v_sub_f32 v158, v158, v164
    v_sub_f32 v159, v159, v164
    v_sub_f32 v160, v160, v164
    v_sub_f32 v161, v161, v164
    v_cvt_pk_bf16_f32 v166, v144, v145
    v_lshlrev_b32 v144, 16, v166
    v_and_b32 v145, s76, v166
    v_cvt_pk_bf16_f32 v166, v146, v147
    v_lshlrev_b32 v146, 16, v166
    v_and_b32 v147, s76, v166
    v_cvt_pk_bf16_f32 v166, v148, v149
    v_lshlrev_b32 v148, 16, v166
    v_and_b32 v149, s76, v166
    v_cvt_pk_bf16_f32 v166, v150, v151
    v_lshlrev_b32 v150, 16, v166
    v_and_b32 v151, s76, v166
    v_cvt_pk_bf16_f32 v166, v152, v153
    v_lshlrev_b32 v152, 16, v166
    v_and_b32 v153, s76, v166
    v_cvt_pk_bf16_f32 v166, v154, v155
    v_lshlrev_b32 v154, 16, v166
    v_and_b32 v155, s76, v166
    v_cvt_pk_bf16_f32 v166, v156, v157
    v_lshlrev_b32 v156, 16, v166
    v_and_b32 v157, s76, v166
    v_cvt_pk_bf16_f32 v166, v158, v159
    v_lshlrev_b32 v158, 16, v166
    v_and_b32 v159, s76, v166
    v_cvt_pk_bf16_f32 v166, v160, v161
    v_lshlrev_b32 v160, 16, v166
    v_and_b32 v161, s76, v166
    v_mul_f32 v144, v144, v165
    v_mul_f32 v145, v145, v165
    v_mul_f32 v146, v146, v165
    v_mul_f32 v147, v147, v165
    v_mul_f32 v148, v148, v165
    v_mul_f32 v149, v149, v165
    v_mul_f32 v150, v150, v165
    v_mul_f32 v151, v151, v165
    v_mul_f32 v152, v152, v165
    v_mul_f32 v153, v153, v165
    v_mul_f32 v154, v154, v165
    v_mul_f32 v155, v155, v165
    v_mul_f32 v156, v156, v165
    v_mul_f32 v157, v157, v165
    v_mul_f32 v158, v158, v165
    v_mul_f32 v159, v159, v165
    v_mul_f32 v160, v160, v165
    v_mul_f32 v161, v161, v165
    v_add_u32 v128, 147456, v128
    v_cvt_pk_bf16_f32 v132, v144, v145
    ds_write_b32 v128, v132 offset:0
    v_cvt_pk_bf16_f32 v133, v146, v147
    ds_write_b32 v128, v133 offset:4
    v_cvt_pk_bf16_f32 v134, v148, v149
    ds_write_b32 v128, v134 offset:8
    v_cvt_pk_bf16_f32 v136, v150, v151
    ds_write_b32 v128, v136 offset:384
    v_cvt_pk_bf16_f32 v137, v152, v153
    ds_write_b32 v128, v137 offset:388
    v_cvt_pk_bf16_f32 v138, v154, v155
    ds_write_b32 v128, v138 offset:392
    v_cvt_pk_bf16_f32 v140, v156, v157
    ds_write_b32 v128, v140 offset:768
    v_cvt_pk_bf16_f32 v141, v158, v159
    ds_write_b32 v128, v141 offset:772
    v_cvt_pk_bf16_f32 v142, v160, v161
    ds_write_b32 v128, v142 offset:776
    v_and_b32 v41, 1, v1
    v_mul_u32_u24 v41, 1152, v41
    v_lshl_add_u32 v41, v58, 4, v41
    s_lshl_b32 s66, s66, 1
    s_add_u32 s66, s66, 147456
    v_add_u32 v130, s66, v41
    s_cmp_lt_u32 s72, 2
    s_cselect_b32 s66, 256, 0
    v_add_u32 v131, s66, v130
    v_bfe_u32 v41, v1, 2, 2
    v_lshl_add_u32 v41, v58, 3, v41
    v_mul_u32_u24 v41, 128, v41
    v_and_b32 v42, 3, v1
    v_lshl_add_u32 v59, v42, 3, v41
    s_lshl_b32 s66, s56, 5
    s_add_u32 s66, s66, 73728
    v_add_u32 v129, s66, v59
    s_waitcnt vmcnt(9) lgkmcnt(0)
    s_barrier
    ds_read_b128 v[168:171], v130 offset:0
    ds_read_b64_tr_b16 v[188:189], v129 offset:0
    ds_read_b64_tr_b16 v[190:191], v129 offset:512
    ds_read_b128 v[172:175], v130 offset:64
    ds_read_b64_tr_b16 v[192:193], v129 offset:4096
    ds_read_b64_tr_b16 v[194:195], v129 offset:4608
    ds_read_b128 v[176:179], v130 offset:128
    ds_read_b64_tr_b16 v[196:197], v129 offset:8192
    ds_read_b64_tr_b16 v[198:199], v129 offset:8704
    ds_read_b128 v[180:183], v130 offset:192
    ds_read_b64_tr_b16 v[200:201], v129 offset:12288
    ds_read_b64_tr_b16 v[202:203], v129 offset:12800
    ds_read_b128 v[184:187], v131
    ds_read_b64_tr_b16 v[204:205], v129 offset:16384
    ds_read_b64_tr_b16 v[206:207], v129 offset:16896
    s_add_u32 s57, s89, 1
    s_and_b32 s57, s57, 0xff
    v_mov_b32 v56, s57
    v_and_b32 v41, 15, v1
    v_lshlrev_b32 v42, 14, v41
    v_lshl_add_u32 v42, v58, 4, v42
    v_cmp_gt_u32 vcc, 2, v41
    v_mov_b32 v43, 0x80000000
    s_nop 0
    v_cndmask_b32 v42, v43, v42, vcc
    s_lshl_b32 s66, s72, 15
    s_lshl_b32 s67, s71, 8
    s_add_u32 s66, s66, s67
    s_lshl_b32 s67, s56, 6
    s_add_u32 s66, s66, s67
    s_add_u32 s66, s66, 4096
    s_waitcnt lgkmcnt(12)
    v_mfma_f32_16x16x32_bf16 v[208:211], v[188:191], v[168:171], 0
    s_waitcnt lgkmcnt(9)
    v_mfma_f32_16x16x32_bf16 v[208:211], v[192:195], v[172:175], v[208:211]
    s_waitcnt lgkmcnt(6)
    v_mfma_f32_16x16x32_bf16 v[208:211], v[196:199], v[176:179], v[208:211]
    s_waitcnt lgkmcnt(3)
    v_mfma_f32_16x16x32_bf16 v[208:211], v[200:203], v[180:183], v[208:211]
    s_waitcnt lgkmcnt(0)
    v_mfma_f32_16x16x32_bf16 v[208:211], v[204:207], v[184:187], v[208:211]
    s_nop 7
    v_bfi_b32 v208, 15, v56, v208
    v_bfi_b32 v209, 15, v56, v209
    v_bfi_b32 v210, 15, v56, v210
    v_bfi_b32 v211, 15, v56, v211
    buffer_store_dwordx4 v[208:211], v42, s[36:39], s66 offen sc1
    s_cmp_eq_u32 s70, 2
    s_cbranch_scc1 L_stage_ffn
    s_cmp_eq_u32 s70, 1
    s_cbranch_scc1 L_stage_o
    s_add_u32 s62, s60, 32768
    buffer_load_dwordx4 v[96:99], v2, s[28:31], s62 offen offset:0 nt
    buffer_load_dwordx4 v[100:103], v2, s[28:31], s62 offen offset:1024 nt
    buffer_load_dwordx4 v[104:107], v2, s[28:31], s62 offen offset:2048 nt
    buffer_load_dwordx4 v[108:111], v2, s[28:31], s62 offen offset:3072 nt
    s_add_u32 s62, s60, 49152
    buffer_load_dwordx4 v[112:115], v2, s[28:31], s62 offen offset:0 nt
    buffer_load_dwordx4 v[116:119], v2, s[28:31], s62 offen offset:1024 nt
    buffer_load_dwordx4 v[120:123], v2, s[28:31], s62 offen offset:2048 nt
    buffer_load_dwordx4 v[124:127], v2, s[28:31], s62 offen offset:3072 nt
    v_bfe_u32 v41, v1, 3, 1
    v_lshlrev_b32 v41, 16, v41
    v_bfe_u32 v42, v1, 2, 1
    v_lshl_add_u32 v41, v42, 9, v41
    v_lshl_add_u32 v41, v58, 7, v41
    v_and_b32 v42, 3, v1
    v_lshl_add_u32 v128, v42, 5, v41
    s_lshl_b32 s65, s80, 10
    s_add_u32 s65, s65, 4096
    s_add_u32 s66, s65, 32768
    s_waitcnt vmcnt(4)
    buffer_load_dwordx4 v[132:135], v128, s[36:39], s65 offen sc1
    buffer_load_dwordx4 v[136:139], v128, s[36:39], s65 offen offset:16 sc1
    buffer_load_dwordx4 v[140:143], v128, s[36:39], s66 offen sc1
    buffer_load_dwordx4 v[144:147], v128, s[36:39], s66 offen offset:16 sc1
L_staged:
    s_lshl_b32 s67, s56, 10
    s_add_u32 s67, s67, 150016
    v_add_u32 v252, s67, v3
    s_lshl_b32 s67, s56, 9
    s_add_u32 s67, s67, 154112
    v_lshl_add_u32 v253, v1, 3, s67
    v_bfe_u32 v41, v1, 2, 1
    v_lshlrev_b32 v42, 9, v41
    v_lshl_add_u32 v42, v58, 7, v42
    v_bfe_u32 v43, v1, 3, 1
    v_lshl_add_u32 v42, v43, 6, v42
    v_and_b32 v43, 3, v1
    v_lshl_add_u32 v254, v43, 4, v42
    v_lshlrev_b32 v41, 4, v41
    v_add_u32 v41, 1024, v41
    v_and_b32 v42, 0x3b, v1
    v_cmp_eq_u32 vcc, 0, v42
    v_mov_b32 v43, 0x80000000
    s_nop 0
    v_cndmask_b32 v255, v43, v41, vcc
    s_mul_i32 s15, s2, 1280
    s_add_u32 s15, s15, 196608
    s_mov_b32 s0, 1280
    s_mov_b32 s1, 0xbfb8aa3b
    s_waitcnt vmcnt(0)
    s_branch L_qchk
L_qagain:
    buffer_load_dwordx4 v[132:135], v128, s[36:39], s65 offen sc1
    buffer_load_dwordx4 v[136:139], v128, s[36:39], s65 offen offset:16 sc1
    buffer_load_dwordx4 v[140:143], v128, s[36:39], s66 offen sc1
    buffer_load_dwordx4 v[144:147], v128, s[36:39], s66 offen offset:16 sc1
    s_waitcnt vmcnt(0)
L_qchk:
    v_and_b32 v43, 15, v56
    v_xor_b32 v132, v132, v43
    v_xor_b32 v133, v133, v43
    v_xor_b32 v134, v134, v43
    v_xor_b32 v135, v135, v43
    v_xor_b32 v136, v136, v43
    v_xor_b32 v137, v137, v43
    v_xor_b32 v138, v138, v43
    v_xor_b32 v139, v139, v43
    v_xor_b32 v140, v140, v43
    v_xor_b32 v141, v141, v43
    v_xor_b32 v142, v142, v43
    v_xor_b32 v143, v143, v43
    v_xor_b32 v144, v144, v43
    v_xor_b32 v145, v145, v43
    v_xor_b32 v146, v146, v43
    v_xor_b32 v147, v147, v43
    v_or3_b32 v41, v132, v133, v134
    v_or3_b32 v41, v41, v135, v136
    v_or3_b32 v41, v41, v137, v138
    v_or3_b32 v41, v41, v139, v140
    v_or3_b32 v41, v41, v141, v142
    v_or3_b32 v41, v41, v143, v144
    v_or3_b32 v41, v41, v145, v146
    v_or_b32 v41, v41, v147
    v_and_b32 v41, 15, v41
    v_cmp_ne_u32 vcc, 0, v41
    s_cbranch_vccz L_qd_2
    s_sub_u32 s73, s73, 1
    s_cbranch_scc0 L_qagain
    s_mov_b32 s73, 0
L_qd_2:
    v_add_f32 v132, v132, v140
    v_add_f32 v133, v133, v141
    v_add_f32 v134, v134, v142
    v_add_f32 v135, v135, v143
    v_add_f32 v136, v136, v144
    v_add_f32 v137, v137, v145
    v_add_f32 v138, v138, v146
    v_add_f32 v139, v139, v147
    v_add_f32_dpp v140, v132, v132 row_ror:8 row_mask:0xf bank_mask:0xf
    v_add_f32_dpp v141, v133, v133 row_ror:8 row_mask:0xf bank_mask:0xf
    v_add_f32_dpp v142, v134, v134 row_ror:8 row_mask:0xf bank_mask:0xf
    v_add_f32_dpp v143, v135, v135 row_ror:8 row_mask:0xf bank_mask:0xf
    v_add_f32_dpp v144, v136, v136 row_ror:8 row_mask:0xf bank_mask:0xf
    v_add_f32_dpp v145, v137, v137 row_ror:8 row_mask:0xf bank_mask:0xf
    v_add_f32_dpp v146, v138, v138 row_ror:8 row_mask:0xf bank_mask:0xf
    v_add_f32_dpp v147, v139, v139 row_ror:8 row_mask:0xf bank_mask:0xf
    v_cvt_pk_bf16_f32 v132, v140, v141
    v_cvt_pk_bf16_f32 v133, v142, v143
    v_cvt_pk_bf16_f32 v134, v144, v145
    v_cvt_pk_bf16_f32 v135, v146, v147
    v_and_b32 v41, 8, v1
    v_cmp_eq_u32 vcc, 0, v41
    s_nop 1
    v_cndmask_b32 v8, 0, v132, vcc
    v_cndmask_b32 v9, 0, v133, vcc
    v_cndmask_b32 v10, 0, v134, vcc
    v_cndmask_b32 v11, 0, v135, vcc
    v_sub_u32 v12, v132, v8
    v_sub_u32 v13, v133, v9
    v_sub_u32 v14, v134, v10
    v_sub_u32 v15, v135, v11
    v_mov_b32 v32, 0
    v_mov_b32 v33, 0
    v_mov_b32 v34, 0
    v_mov_b32 v35, 0
    v_mov_b32 v36, 0xff61b1e6
    v_mov_b32 v37, 0
    s_waitcnt lgkmcnt(0)
    s_mov_b32 s86, 8388608
    s_mov_b32 s87, 0x20000
    s_add_u32 s61, s60, 131072
    s_add_u32 s88, s60, 147456
    s_cmp_gt_u32 s63, 1
    s_cselect_b64 s[74:75], -1, 0
    s_cselect_b32 s84, s28, s32
    s_cselect_b32 s85, s29, s33
    s_cselect_b32 s88, s88, s61
    v_cndmask_b32 v57, v3, v2, s[74:75]
    s_add_u32 s65, s63, s64
    s_cmp_gt_u32 s65, 1
    s_cselect_b32 s61, s61, 0x80000000
    s_cselect_b32 s88, s88, 0x80000000
    v_mfma_f32_16x16x32_bf16 v[16:19], v[64:67], v[8:11], 0
    v_mfma_f32_16x16x32_bf16 v[16:19], v[68:71], v[12:15], v[16:19]
    v_mfma_f32_16x16x32_bf16 v[20:23], v[72:75], v[8:11], 0
    v_mfma_f32_16x16x32_bf16 v[20:23], v[76:79], v[12:15], v[20:23]
    s_nop 5
    v_mov_b32_dpp v128, v16 quad_perm:[0,0,0,0] row_mask:0xf bank_mask:0xf
    v_add_f32_dpp v128, v17, v128 quad_perm:[1,1,1,1] row_mask:0xf bank_mask:0xf
    v_add_f32_dpp v128, v18, v128 quad_perm:[2,2,2,2] row_mask:0xf bank_mask:0xf
    v_add_f32_dpp v128, v19, v128 quad_perm:[3,3,3,3] row_mask:0xf bank_mask:0xf
    v_mfma_f32_16x16x32_bf16 v[16:19], v[80:83], v[8:11], 0
    v_mfma_f32_16x16x32_bf16 v[16:19], v[84:87], v[12:15], v[16:19]
    v_mov_b32_dpp v129, v20 quad_perm:[0,0,0,0] row_mask:0xf bank_mask:0xf
    v_add_f32_dpp v129, v21, v129 quad_perm:[1,1,1,1] row_mask:0xf bank_mask:0xf
    v_add_f32_dpp v129, v22, v129 quad_perm:[2,2,2,2] row_mask:0xf bank_mask:0xf
    v_add_f32_dpp v129, v23, v129 quad_perm:[3,3,3,3] row_mask:0xf bank_mask:0xf
    v_mfma_f32_16x16x32_bf16 v[20:23], v[88:91], v[8:11], 0
    v_cvt_pk_bf16_f32 v41, v128, v129
    v_lshlrev_b32 v128, 16, v41
    v_and_b32 v129, s76, v41
    v_mul_f32 v128, s77, v128
    v_mul_f32 v129, s77, v129
    v_cvt_pk_bf16_f32 v41, v128, v129
    v_lshlrev_b32 v128, 16, v41
    v_and_b32 v129, s76, v41
    v_max3_f32 v40, v36, v128, v129
    v_mfma_f32_16x16x32_bf16 v[20:23], v[92:95], v[12:15], v[20:23]
    v_mov_b32_dpp v130, v16 quad_perm:[0,0,0,0] row_mask:0xf bank_mask:0xf
    v_add_f32_dpp v130, v17, v130 quad_perm:[1,1,1,1] row_mask:0xf bank_mask:0xf
    v_add_f32_dpp v130, v18, v130 quad_perm:[2,2,2,2] row_mask:0xf bank_mask:0xf
    v_add_f32_dpp v130, v19, v130 quad_perm:[3,3,3,3] row_mask:0xf bank_mask:0xf
    v_mfma_f32_16x16x32_bf16 v[16:19], v[96:99], v[8:11], 0
    v_mfma_f32_16x16x32_bf16 v[16:19], v[100:103], v[12:15], v[16:19]
    s_nop 1
    v_mov_b32_dpp v131, v20 quad_perm:[0,0,0,0] row_mask:0xf bank_mask:0xf
    v_add_f32_dpp v131, v21, v131 quad_perm:[1,1,1,1] row_mask:0xf bank_mask:0xf
    v_add_f32_dpp v131, v22, v131 quad_perm:[2,2,2,2] row_mask:0xf bank_mask:0xf
    v_add_f32_dpp v131, v23, v131 quad_perm:[3,3,3,3] row_mask:0xf bank_mask:0xf
    v_mfma_f32_16x16x32_bf16 v[20:23], v[104:107], v[8:11], 0
    s_add_u32 s62, s60, 65536
    buffer_load_dwordx4 v[64:67], v2, s[28:31], s62 offen offset:0 nt
    v_cvt_pk_bf16_f32 v41, v130, v131
    v_lshlrev_b32 v130, 16, v41
    v_and_b32 v131, s76, v41
    v_mul_f32 v130, s77, v130
    v_mul_f32 v131, s77, v131
    v_cvt_pk_bf16_f32 v41, v130, v131
    v_lshlrev_b32 v130, 16, v41
    v_and_b32 v131, s76, v41
    v_max3_f32 v40, v40, v130, v131
    v_mfma_f32_16x16x32_bf16 v[20:23], v[108:111], v[12:15], v[20:23]
    buffer_load_dwordx4 v[68:71], v2, s[28:31], s62 offen offset:1024 nt
    v_mov_b32_dpp v132, v16 quad_perm:[0,0,0,0] row_mask:0xf bank_mask:0xf
    v_add_f32_dpp v132, v17, v132 quad_perm:[1,1,1,1] row_mask:0xf bank_mask:0xf
    v_add_f32_dpp v132, v18, v132 quad_perm:[2,2,2,2] row_mask:0xf bank_mask:0xf
    v_add_f32_dpp v132, v19, v132 quad_perm:[3,3,3,3] row_mask:0xf bank_mask:0xf
    v_mfma_f32_16x16x32_bf16 v[16:19], v[112:115], v[8:11], 0
    buffer_load_dwordx4 v[72:75], v2, s[28:31], s62 offen offset:2048 nt
    v_mfma_f32_16x16x32_bf16 v[16:19], v[116:119], v[12:15], v[16:19]
    buffer_load_dwordx4 v[76:79], v2, s[28:31], s62 offen offset:3072 nt
    v_mov_b32_dpp v133, v20 quad_perm:[0,0,0,0] row_mask:0xf bank_mask:0xf
    v_add_f32_dpp v133, v21, v133 quad_perm:[1,1,1,1] row_mask:0xf bank_mask:0xf
    v_add_f32_dpp v133, v22, v133 quad_perm:[2,2,2,2] row_mask:0xf bank_mask:0xf
    v_add_f32_dpp v133, v23, v133 quad_perm:[3,3,3,3] row_mask:0xf bank_mask:0xf
    v_mfma_f32_16x16x32_bf16 v[20:23], v[120:123], v[8:11], 0
    s_add_u32 s62, s60, 81920
    buffer_load_dwordx4 v[80:83], v2, s[28:31], s62 offen offset:0 nt
    v_cvt_pk_bf16_f32 v41, v132, v133
    v_lshlrev_b32 v132, 16, v41
    v_and_b32 v133, s76, v41
    v_mul_f32 v132, s77, v132
    v_mul_f32 v133, s77, v133
    v_cvt_pk_bf16_f32 v41, v132, v133
    v_lshlrev_b32 v132, 16, v41
    v_and_b32 v133, s76, v41
    v_max3_f32 v40, v40, v132, v133
    v_mfma_f32_16x16x32_bf16 v[20:23], v[124:127], v[12:15], v[20:23]
    buffer_load_dwordx4 v[84:87], v2, s[28:31], s62 offen offset:1024 nt
    v_mov_b32_dpp v134, v16 quad_perm:[0,0,0,0] row_mask:0xf bank_mask:0xf
    v_add_f32_dpp v134, v17, v134 quad_perm:[1,1,1,1] row_mask:0xf bank_mask:0xf
    v_add_f32_dpp v134, v18, v134 quad_perm:[2,2,2,2] row_mask:0xf bank_mask:0xf
    v_add_f32_dpp v134, v19, v134 quad_perm:[3,3,3,3] row_mask:0xf bank_mask:0xf
    s_branch L_join
.p2align 6
L_big:
    s_waitcnt vmcnt(5)
    v_mfma_f32_16x16x32_bf16 v[16:19], v[64:67], v[8:11], 0
    s_add_u32 s62, s60, 16384
    buffer_load_dwordx4 v[88:91], v2, s[28:31], s62 offen offset:2048 nt
    s_waitcnt vmcnt(5)
    v_mfma_f32_16x16x32_bf16 v[16:19], v[68:71], v[12:15], v[16:19]
    buffer_load_dwordx4 v[92:95], v2, s[28:31], s62 offen offset:3072 nt
    s_waitcnt vmcnt(5)
    v_mfma_f32_16x16x32_bf16 v[20:23], v[72:75], v[8:11], 0
    s_add_u32 s62, s60, 32768
    buffer_load_dwordx4 v[96:99], v2, s[28:31], s62 offen offset:0 nt
    s_waitcnt vmcnt(5)
    v_mfma_f32_16x16x32_bf16 v[20:23], v[76:79], v[12:15], v[20:23]
    buffer_load_dwordx4 v[100:103], v2, s[28:31], s62 offen offset:1024 nt
    v_mov_b32_dpp v128, v16 quad_perm:[0,0,0,0] row_mask:0xf bank_mask:0xf
    v_add_f32_dpp v128, v17, v128 quad_perm:[1,1,1,1] row_mask:0xf bank_mask:0xf
    v_add_f32_dpp v128, v18, v128 quad_perm:[2,2,2,2] row_mask:0xf bank_mask:0xf
    v_add_f32_dpp v128, v19, v128 quad_perm:[3,3,3,3] row_mask:0xf bank_mask:0xf
    s_waitcnt vmcnt(5)
    v_mfma_f32_16x16x32_bf16 v[16:19], v[80:83], v[8:11], 0
    buffer_load_dwordx4 v[104:107], v2, s[28:31], s62 offen offset:2048 nt
    s_waitcnt vmcnt(5)
    v_mfma_f32_16x16x32_bf16 v[16:19], v[84:87], v[12:15], v[16:19]
    buffer_load_dwordx4 v[108:111], v2, s[28:31], s62 offen offset:3072 nt
    v_mov_b32_dpp v129, v20 quad_perm:[0,0,0,0] row_mask:0xf bank_mask:0xf
    v_add_f32_dpp v129, v21, v129 quad_perm:[1,1,1,1] row_mask:0xf bank_mask:0xf
    v_add_f32_dpp v129, v22, v129 quad_perm:[2,2,2,2] row_mask:0xf bank_mask:0xf
    v_add_f32_dpp v129, v23, v129 quad_perm:[3,3,3,3] row_mask:0xf bank_mask:0xf
    s_waitcnt vmcnt(5)
    v_mfma_f32_16x16x32_bf16 v[20:23], v[88:91], v[8:11], 0
    s_add_u32 s62, s60, 49152
    buffer_load_dwordx4 v[112:115], v2, s[28:31], s62 offen offset:0 nt
    v_cvt_pk_bf16_f32 v41, v128, v129
    v_lshlrev_b32 v128, 16, v41
    v_and_b32 v129, s76, v41
    v_mul_f32 v128, s77, v128
    v_mul_f32 v129, s77, v129
    v_cvt_pk_bf16_f32 v41, v128, v129
    v_lshlrev_b32 v128, 16, v41
    v_and_b32 v129, s76, v41
    v_max3_f32 v40, v36, v128, v129
    s_waitcnt vmcnt(5)
    v_mfma_f32_16x16x32_bf16 v[20:23], v[92:95], v[12:15], v[20:23]
    buffer_load_dwordx4 v[116:119], v2, s[28:31], s62 offen offset:1024 nt
    v_mov_b32_dpp v130, v16 quad_perm:[0,0,0,0] row_mask:0xf bank_mask:0xf
    v_add_f32_dpp v130, v17, v130 quad_perm:[1,1,1,1] row_mask:0xf bank_mask:0xf
    v_add_f32_dpp v130, v18, v130 quad_perm:[2,2,2,2] row_mask:0xf bank_mask:0xf
    v_add_f32_dpp v130, v19, v130 quad_perm:[3,3,3,3] row_mask:0xf bank_mask:0xf
    s_waitcnt vmcnt(5)
    v_mfma_f32_16x16x32_bf16 v[16:19], v[96:99], v[8:11], 0
    buffer_load_dwordx4 v[120:123], v2, s[28:31], s62 offen offset:2048 nt
    s_waitcnt vmcnt(5)
    v_mfma_f32_16x16x32_bf16 v[16:19], v[100:103], v[12:15], v[16:19]
    buffer_load_dwordx4 v[124:127], v2, s[28:31], s62 offen offset:3072 nt
    v_mov_b32_dpp v131, v20 quad_perm:[0,0,0,0] row_mask:0xf bank_mask:0xf
    v_add_f32_dpp v131, v21, v131 quad_perm:[1,1,1,1] row_mask:0xf bank_mask:0xf
    v_add_f32_dpp v131, v22, v131 quad_perm:[2,2,2,2] row_mask:0xf bank_mask:0xf
    v_add_f32_dpp v131, v23, v131 quad_perm:[3,3,3,3] row_mask:0xf bank_mask:0xf
    s_waitcnt vmcnt(5)
    v_mfma_f32_16x16x32_bf16 v[20:23], v[104:107], v[8:11], 0
    s_add_u32 s62, s60, 65536
    buffer_load_dwordx4 v[64:67], v2, s[28:31], s62 offen offset:0 nt
    v_cvt_pk_bf16_f32 v41, v130, v131
    v_lshlrev_b32 v130, 16, v41
    v_and_b32 v131, s76, v41
    v_mul_f32 v130, s77, v130
    v_mul_f32 v131, s77, v131
    v_cvt_pk_bf16_f32 v41, v130, v131
    v_lshlrev_b32 v130, 16, v41
    v_and_b32 v131, s76, v41
    v_max3_f32 v40, v40, v130, v131
    s_waitcnt vmcnt(5)
    v_mfma_f32_16x16x32_bf16 v[20:23], v[108:111], v[12:15], v[20:23]
    buffer_load_dwordx4 v[68:71], v2, s[28:31], s62 offen offset:1024 nt
    v_mov_b32_dpp v132, v16 quad_perm:[0,0,0,0] row_mask:0xf bank_mask:0xf
    v_add_f32_dpp v132, v17, v132 quad_perm:[1,1,1,1] row_mask:0xf bank_mask:0xf
    v_add_f32_dpp v132, v18, v132 quad_perm:[2,2,2,2] row_mask:0xf bank_mask:0xf
    v_add_f32_dpp v132, v19, v132 quad_perm:[3,3,3,3] row_mask:0xf bank_mask:0xf
    s_waitcnt vmcnt(5)
    v_mfma_f32_16x16x32_bf16 v[16:19], v[112:115], v[8:11], 0
    buffer_load_dwordx4 v[72:75], v2, s[28:31], s62 offen offset:2048 nt
    s_waitcnt vmcnt(5)
    v_mfma_f32_16x16x32_bf16 v[16:19], v[116:119], v[12:15], v[16:19]
    buffer_load_dwordx4 v[76:79], v2, s[28:31], s62 offen offset:3072 nt
    v_mov_b32_dpp v133, v20 quad_perm:[0,0,0,0] row_mask:0xf bank_mask:0xf
    v_add_f32_dpp v133, v21, v133 quad_perm:[1,1,1,1] row_mask:0xf bank_mask:0xf
    v_add_f32_dpp v133, v22, v133 quad_perm:[2,2,2,2] row_mask:0xf bank_mask:0xf
    v_add_f32_dpp v133, v23, v133 quad_perm:[3,3,3,3] row_mask:0xf bank_mask:0xf
    s_waitcnt vmcnt(5)
    v_mfma_f32_16x16x32_bf16 v[20:23], v[120:123], v[8:11], 0
    s_add_u32 s62, s60, 81920
    buffer_load_dwordx4 v[80:83], v2, s[28:31], s62 offen offset:0 nt
    v_cvt_pk_bf16_f32 v41, v132, v133
    v_lshlrev_b32 v132, 16, v41
    v_and_b32 v133, s76, v41
    v_mul_f32 v132, s77, v132
    v_mul_f32 v133, s77, v133
    v_cvt_pk_bf16_f32 v41, v132, v133
    v_lshlrev_b32 v132, 16, v41
    v_and_b32 v133, s76, v41
    v_max3_f32 v40, v40, v132, v133
    s_waitcnt vmcnt(5)
    v_mfma_f32_16x16x32_bf16 v[20:23], v[124:127], v[12:15], v[20:23]
    buffer_load_dwordx4 v[84:87], v2, s[28:31], s62 offen offset:1024 nt
    v_mov_b32_dpp v134, v16 quad_perm:[0,0,0,0] row_mask:0xf bank_mask:0xf
    v_add_f32_dpp v134, v17, v134 quad_perm:[1,1,1,1] row_mask:0xf bank_mask:0xf
    v_add_f32_dpp v134, v18, v134 quad_perm:[2,2,2,2] row_mask:0xf bank_mask:0xf
    v_add_f32_dpp v134, v19, v134 quad_perm:[3,3,3,3] row_mask:0xf bank_mask:0xf
L_join:
    s_waitcnt vmcnt(5)
    v_mfma_f32_16x16x32_bf16 v[16:19], v[64:67], v[8:11], 0
    buffer_load_dwordx4 v[88:91], v2, s[28:31], s62 offen offset:2048 nt
    s_waitcnt vmcnt(5)
    v_mfma_f32_16x16x32_bf16 v[16:19], v[68:71], v[12:15], v[16:19]
    buffer_load_dwordx4 v[92:95], v2, s[28:31], s62 offen offset:3072 nt
    v_mov_b32_dpp v135, v20 quad_perm:[0,0,0,0] row_mask:0xf bank_mask:0xf
    v_add_f32_dpp v135, v21, v135 quad_perm:[1,1,1,1] row_mask:0xf bank_mask:0xf
    v_add_f32_dpp v135, v22, v135 quad_perm:[2,2,2,2] row_mask:0xf bank_mask:0xf
    v_add_f32_dpp v135, v23, v135 quad_perm:[3,3,3,3] row_mask:0xf bank_mask:0xf
    s_waitcnt vmcnt(5)
    v_mfma_f32_16x16x32_bf16 v[20:23], v[72:75], v[8:11], 0
    s_add_u32 s62, s60, 98304
    buffer_load_dwordx4 v[96:99], v2, s[28:31], s62 offen offset:0 nt
    v_cvt_pk_bf16_f32 v41, v134, v135
    v_lshlrev_b32 v134, 16, v41
    v_and_b32 v135, s76, v41
    v_mul_f32 v134, s77, v134
    v_mul_f32 v135, s77, v135
    v_cvt_pk_bf16_f32 v41, v134, v135
    v_lshlrev_b32 v134, 16, v41
    v_and_b32 v135, s76, v41
    v_max3_f32 v40, v40, v134, v135
    s_waitcnt vmcnt(5)
    v_mfma_f32_16x16x32_bf16 v[20:23], v[76:79], v[12:15], v[20:23]
    buffer_load_dwordx4 v[100:103], v2, s[28:31], s62 offen offset:1024 nt
    v_mov_b32_dpp v136, v16 quad_perm:[0,0,0,0] row_mask:0xf bank_mask:0xf
    v_add_f32_dpp v136, v17, v136 quad_perm:[1,1,1,1] row_mask:0xf bank_mask:0xf
    v_add_f32_dpp v136, v18, v136 quad_perm:[2,2,2,2] row_mask:0xf bank_mask:0xf
    v_add_f32_dpp v136, v19, v136 quad_perm:[3,3,3,3] row_mask:0xf bank_mask:0xf
    s_waitcnt vmcnt(5)
    v_mfma_f32_16x16x32_bf16 v[16:19], v[80:83], v[8:11], 0
    buffer_load_dwordx4 v[104:107], v2, s[28:31], s62 offen offset:2048 nt
    s_waitcnt vmcnt(5)
    v_mfma_f32_16x16x32_bf16 v[16:19], v[84:87], v[12:15], v[16:19]
    buffer_load_dwordx4 v[108:111], v2, s[28:31], s62 offen offset:3072 nt
    v_mov_b32_dpp v137, v20 quad_perm:[0,0,0,0] row_mask:0xf bank_mask:0xf
    v_add_f32_dpp v137, v21, v137 quad_perm:[1,1,1,1] row_mask:0xf bank_mask:0xf
    v_add_f32_dpp v137, v22, v137 quad_perm:[2,2,2,2] row_mask:0xf bank_mask:0xf
    v_add_f32_dpp v137, v23, v137 quad_perm:[3,3,3,3] row_mask:0xf bank_mask:0xf
    s_waitcnt vmcnt(5)
    v_mfma_f32_16x16x32_bf16 v[20:23], v[88:91], v[8:11], 0
    s_add_u32 s62, s60, 114688
    buffer_load_dwordx4 v[112:115], v2, s[28:31], s62 offen offset:0 nt
    v_cvt_pk_bf16_f32 v41, v136, v137
    v_lshlrev_b32 v136, 16, v41
    v_and_b32 v137, s76, v41
    v_mul_f32 v136, s77, v136
    v_mul_f32 v137, s77, v137
    v_cvt_pk_bf16_f32 v41, v136, v137
    v_lshlrev_b32 v136, 16, v41
    v_and_b32 v137, s76, v41
    v_max3_f32 v40, v40, v136, v137
    s_waitcnt vmcnt(5)
    v_mfma_f32_16x16x32_bf16 v[20:23], v[92:95], v[12:15], v[20:23]
    buffer_load_dwordx4 v[116:119], v2, s[28:31], s62 offen offset:1024 nt
    v_mov_b32_dpp v138, v16 quad_perm:[0,0,0,0] row_mask:0xf bank_mask:0xf
    v_add_f32_dpp v138, v17, v138 quad_perm:[1,1,1,1] row_mask:0xf bank_mask:0xf
    v_add_f32_dpp v138, v18, v138 quad_perm:[2,2,2,2] row_mask:0xf bank_mask:0xf
    v_add_f32_dpp v138, v19, v138 quad_perm:[3,3,3,3] row_mask:0xf bank_mask:0xf
    s_waitcnt vmcnt(5)
    v_mfma_f32_16x16x32_bf16 v[16:19], v[96:99], v[8:11], 0
    buffer_load_dwordx4 v[120:123], v2, s[28:31], s62 offen offset:2048 nt
    s_waitcnt vmcnt(5)
    v_mfma_f32_16x16x32_bf16 v[16:19], v[100:103], v[12:15], v[16:19]
    buffer_load_dwordx4 v[124:127], v2, s[28:31], s62 offen offset:3072 nt
    v_mov_b32_dpp v139, v20 quad_perm:[0,0,0,0] row_mask:0xf bank_mask:0xf
    v_add_f32_dpp v139, v21, v139 quad_perm:[1,1,1,1] row_mask:0xf bank_mask:0xf
    v_add_f32_dpp v139, v22, v139 quad_perm:[2,2,2,2] row_mask:0xf bank_mask:0xf
    v_add_f32_dpp v139, v23, v139 quad_perm:[3,3,3,3] row_mask:0xf bank_mask:0xf
    s_waitcnt vmcnt(5)
    v_mfma_f32_16x16x32_bf16 v[20:23], v[104:107], v[8:11], 0
    buffer_load_dwordx4 v[64:67], v3, s[32:35], s60 offen offset:0 nt
    v_cvt_pk_bf16_f32 v41, v138, v139
    v_lshlrev_b32 v138, 16, v41
    v_and_b32 v139, s76, v41
    v_mul_f32 v138, s77, v138
    v_mul_f32 v139, s77, v139
    v_cvt_pk_bf16_f32 v41, v138, v139
    v_lshlrev_b32 v138, 16, v41
    v_and_b32 v139, s76, v41
    v_max3_f32 v40, v40, v138, v139
    s_waitcnt vmcnt(5)
    v_mfma_f32_16x16x32_bf16 v[20:23], v[108:111], v[12:15], v[20:23]
    buffer_load_dwordx4 v[68:71], v3, s[32:35], s60 offen offset:1024 nt
    v_mov_b32_dpp v140, v16 quad_perm:[0,0,0,0] row_mask:0xf bank_mask:0xf
    v_add_f32_dpp v140, v17, v140 quad_perm:[1,1,1,1] row_mask:0xf bank_mask:0xf
    v_add_f32_dpp v140, v18, v140 quad_perm:[2,2,2,2] row_mask:0xf bank_mask:0xf
    v_add_f32_dpp v140, v19, v140 quad_perm:[3,3,3,3] row_mask:0xf bank_mask:0xf
    s_waitcnt vmcnt(5)
    v_mfma_f32_16x16x32_bf16 v[16:19], v[112:115], v[8:11], 0
    buffer_load_dwordx4 v[72:75], v3, s[32:35], s60 offen offset:2048 nt
    s_waitcnt vmcnt(5)
    v_mfma_f32_16x16x32_bf16 v[16:19], v[116:119], v[12:15], v[16:19]
    buffer_load_dwordx4 v[76:79], v3, s[32:35], s60 offen offset:3072 nt
    v_mov_b32_dpp v141, v20 quad_perm:[0,0,0,0] row_mask:0xf bank_mask:0xf
    v_add_f32_dpp v141, v21, v141 quad_perm:[1,1,1,1] row_mask:0xf bank_mask:0xf
    v_add_f32_dpp v141, v22, v141 quad_perm:[2,2,2,2] row_mask:0xf bank_mask:0xf
    v_add_f32_dpp v141, v23, v141 quad_perm:[3,3,3,3] row_mask:0xf bank_mask:0xf
    s_waitcnt vmcnt(5)
    v_mfma_f32_16x16x32_bf16 v[20:23], v[120:123], v[8:11], 0
    s_add_u32 s62, s60, 16384
    buffer_load_dwordx4 v[80:83], v3, s[32:35], s62 offen offset:0 nt
    v_cvt_pk_bf16_f32 v41, v140, v141
    v_lshlrev_b32 v140, 16, v41
    v_and_b32 v141, s76, v41
    v_mul_f32 v140, s77, v140
    v_mul_f32 v141, s77, v141
    v_cvt_pk_bf16_f32 v41, v140, v141
    v_lshlrev_b32 v140, 16, v41
    v_and_b32 v141, s76, v41
    v_max3_f32 v40, v40, v140, v141
    s_waitcnt vmcnt(5)
    v_mfma_f32_16x16x32_bf16 v[20:23], v[124:127], v[12:15], v[20:23]
    buffer_load_dwordx4 v[84:87], v3, s[32:35], s62 offen offset:1024 nt
    v_mov_b32_dpp v142, v16 quad_perm:[0,0,0,0] row_mask:0xf bank_mask:0xf
    v_add_f32_dpp v142, v17, v142 quad_perm:[1,1,1,1] row_mask:0xf bank_mask:0xf
    v_add_f32_dpp v142, v18, v142 quad_perm:[2,2,2,2] row_mask:0xf bank_mask:0xf
    v_add_f32_dpp v142, v19, v142 quad_perm:[3,3,3,3] row_mask:0xf bank_mask:0xf
    s_nop 2
    v_mov_b32_dpp v143, v20 quad_perm:[0,0,0,0] row_mask:0xf bank_mask:0xf
    v_add_f32_dpp v143, v21, v143 quad_perm:[1,1,1,1] row_mask:0xf bank_mask:0xf
    v_add_f32_dpp v143, v22, v143 quad_perm:[2,2,2,2] row_mask:0xf bank_mask:0xf
    v_add_f32_dpp v143, v23, v143 quad_perm:[3,3,3,3] row_mask:0xf bank_mask:0xf
    v_cvt_pk_bf16_f32 v41, v142, v143
    v_lshlrev_b32 v142, 16, v41
    v_and_b32 v143, s76, v41
    v_mul_f32 v142, s77, v142
    v_mul_f32 v143, s77, v143
    v_cvt_pk_bf16_f32 v41, v142, v143
    v_lshlrev_b32 v142, 16, v41
    v_and_b32 v143, s76, v41
    v_max3_f32 v40, v40, v142, v143
    s_nop 1
    v_max_f32_dpp v40, v40, v40 row_ror:8 row_mask:0xf bank_mask:0xf
    v_mov_b32 v41, v40
    s_nop 1
    v_permlane16_swap_b32 v40, v41
    v_max_f32 v40, v40, v41
    v_mov_b32 v41, v40
    s_nop 1
    v_permlane32_swap_b32 v40, v41
    v_max_f32 v40, v40, v41
    v_sub_f32 v38, v36, v40
    v_mul_f32 v39, s78, v40
    v_mul_f32 v38, s78, v38
    v_sub_f32 v39, 0, v39
    v_exp_f32 v38, v38
    v_mov_b32 v36, v40
    v_mul_f32 v37, v37, v38
    v_fma_f32 v128, v128, s78, v39
    v_exp_f32 v128, v128
    s_nop 0
    v_add_f32 v37, v37, v128
    v_cvt_pk_bf16_f32 v128, v128, v128
    v_mul_f32 v32, v32, v38
    v_mul_f32 v33, v33, v38
    v_mul_f32 v34, v34, v38
    v_mul_f32 v35, v35, v38
    v_and_b32 v48, v128, v4
    v_and_b32 v49, v128, v5
    v_and_b32_dpp v50, v128, v6 row_ror:8 row_mask:0xf bank_mask:0xf
    v_and_b32_dpp v51, v128, v7 row_ror:8 row_mask:0xf bank_mask:0xf
    s_waitcnt vmcnt(5)
    s_nop 0
    v_mfma_f32_16x16x32_bf16 v[32:35], v[64:67], v[48:51], v[32:35]
    buffer_load_dwordx4 v[88:91], v3, s[32:35], s62 offen offset:2048 nt
    v_fma_f32 v129, v129, s78, v39
    v_exp_f32 v129, v129
    s_nop 0
    v_add_f32 v37, v37, v129
    v_cvt_pk_bf16_f32 v129, v129, v129
    v_and_b32_dpp v52, v128, v4 row_ror:8 row_mask:0xf bank_mask:0xf
    v_and_b32_dpp v53, v128, v5 row_ror:8 row_mask:0xf bank_mask:0xf
    v_and_b32 v54, v128, v6
    v_and_b32 v55, v128, v7
    s_waitcnt vmcnt(5)
    s_nop 0
    v_mfma_f32_16x16x32_bf16 v[32:35], v[68:71], v[52:55], v[32:35]
    buffer_load_dwordx4 v[92:95], v3, s[32:35], s62 offen offset:3072 nt
    v_and_b32 v48, v129, v4
    v_and_b32 v49, v129, v5
    v_and_b32_dpp v50, v129, v6 row_ror:8 row_mask:0xf bank_mask:0xf
    v_and_b32_dpp v51, v129, v7 row_ror:8 row_mask:0xf bank_mask:0xf
    s_waitcnt vmcnt(5)
    s_nop 0
    v_mfma_f32_16x16x32_bf16 v[32:35], v[72:75], v[48:51], v[32:35]
    s_add_u32 s62, s60, 32768
    buffer_load_dwordx4 v[96:99], v3, s[32:35], s62 offen offset:0 nt
    v_fma_f32 v130, v130, s78, v39
    v_exp_f32 v130, v130
    s_nop 0
    v_add_f32 v37, v37, v130
    v_cvt_pk_bf16_f32 v130, v130, v130
    v_and_b32_dpp v52, v129, v4 row_ror:8 row_mask:0xf bank_mask:0xf
    v_and_b32_dpp v53, v129, v5 row_ror:8 row_mask:0xf bank_mask:0xf
    v_and_b32 v54, v129, v6
    v_and_b32 v55, v129, v7
    s_waitcnt vmcnt(5)
    s_nop 0
    v_mfma_f32_16x16x32_bf16 v[32:35], v[76:79], v[52:55], v[32:35]
    buffer_load_dwordx4 v[100:103], v3, s[32:35], s62 offen offset:1024 nt
    v_and_b32 v48, v130, v4
    v_and_b32 v49, v130, v5
    v_and_b32_dpp v50, v130, v6 row_ror:8 row_mask:0xf bank_mask:0xf
    v_and_b32_dpp v51, v130, v7 row_ror:8 row_mask:0xf bank_mask:0xf
    s_waitcnt vmcnt(5)
    s_nop 0
    v_mfma_f32_16x16x32_bf16 v[32:35], v[80:83], v[48:51], v[32:35]
    buffer_load_dwordx4 v[104:107], v3, s[32:35], s62 offen offset:2048 nt
    v_fma_f32 v131, v131, s78, v39
    v_exp_f32 v131, v131
    s_nop 0
    v_add_f32 v37, v37, v131
    v_cvt_pk_bf16_f32 v131, v131, v131
    v_and_b32_dpp v52, v130, v4 row_ror:8 row_mask:0xf bank_mask:0xf
    v_and_b32_dpp v53, v130, v5 row_ror:8 row_mask:0xf bank_mask:0xf
    v_and_b32 v54, v130, v6
    v_and_b32 v55, v130, v7
    s_waitcnt vmcnt(5)
    s_nop 0
    v_mfma_f32_16x16x32_bf16 v[32:35], v[84:87], v[52:55], v[32:35]
    buffer_load_dwordx4 v[108:111], v3, s[32:35], s62 offen offset:3072 nt
    v_and_b32 v48, v131, v4
    v_and_b32 v49, v131, v5
    v_and_b32_dpp v50, v131, v6 row_ror:8 row_mask:0xf bank_mask:0xf
    v_and_b32_dpp v51, v131, v7 row_ror:8 row_mask:0xf bank_mask:0xf
    s_waitcnt vmcnt(5)
    s_nop 0
    v_mfma_f32_16x16x32_bf16 v[32:35], v[88:91], v[48:51], v[32:35]
    s_add_u32 s62, s60, 49152
    buffer_load_dwordx4 v[112:115], v3, s[32:35], s62 offen offset:0 nt
    v_fma_f32 v132, v132, s78, v39
    v_exp_f32 v132, v132
    s_nop 0
    v_add_f32 v37, v37, v132
    v_cvt_pk_bf16_f32 v132, v132, v132
    v_and_b32_dpp v52, v131, v4 row_ror:8 row_mask:0xf bank_mask:0xf
    v_and_b32_dpp v53, v131, v5 row_ror:8 row_mask:0xf bank_mask:0xf
    v_and_b32 v54, v131, v6
    v_and_b32 v55, v131, v7
    s_waitcnt vmcnt(5)
    s_nop 0
    v_mfma_f32_16x16x32_bf16 v[32:35], v[92:95], v[52:55], v[32:35]
    buffer_load_dwordx4 v[116:119], v3, s[32:35], s62 offen offset:1024 nt
    v_and_b32 v48, v132, v4
    v_and_b32 v49, v132, v5
    v_and_b32_dpp v50, v132, v6 row_ror:8 row_mask:0xf bank_mask:0xf
    v_and_b32_dpp v51, v132, v7 row_ror:8 row_mask:0xf bank_mask:0xf
    s_waitcnt vmcnt(5)
    s_nop 0
    v_mfma_f32_16x16x32_bf16 v[32:35], v[96:99], v[48:51], v[32:35]
    buffer_load_dwordx4 v[120:123], v3, s[32:35], s62 offen offset:2048 nt
    v_fma_f32 v133, v133, s78, v39
    v_exp_f32 v133, v133
    s_nop 0
    v_add_f32 v37, v37, v133
    v_cvt_pk_bf16_f32 v133, v133, v133
    v_and_b32_dpp v52, v132, v4 row_ror:8 row_mask:0xf bank_mask:0xf
    v_and_b32_dpp v53, v132, v5 row_ror:8 row_mask:0xf bank_mask:0xf
    v_and_b32 v54, v132, v6
    v_and_b32 v55, v132, v7
    s_waitcnt vmcnt(5)
    s_nop 0
    v_mfma_f32_16x16x32_bf16 v[32:35], v[100:103], v[52:55], v[32:35]
    buffer_load_dwordx4 v[124:127], v3, s[32:35], s62 offen offset:3072 nt
    v_and_b32 v48, v133, v4
    v_and_b32 v49, v133, v5
    v_and_b32_dpp v50, v133, v6 row_ror:8 row_mask:0xf bank_mask:0xf
    v_and_b32_dpp v51, v133, v7 row_ror:8 row_mask:0xf bank_mask:0xf
    s_waitcnt vmcnt(5)
    s_nop 0
    v_mfma_f32_16x16x32_bf16 v[32:35], v[104:107], v[48:51], v[32:35]
    s_add_u32 s62, s60, 65536
    buffer_load_dwordx4 v[64:67], v3, s[32:35], s62 offen offset:0 nt
    v_fma_f32 v134, v134, s78, v39
    v_exp_f32 v134, v134
    s_nop 0
    v_add_f32 v37, v37, v134
    v_cvt_pk_bf16_f32 v134, v134, v134
    v_and_b32_dpp v52, v133, v4 row_ror:8 row_mask:0xf bank_mask:0xf
    v_and_b32_dpp v53, v133, v5 row_ror:8 row_mask:0xf bank_mask:0xf
    v_and_b32 v54, v133, v6
    v_and_b32 v55, v133, v7
    s_waitcnt vmcnt(5)
    s_nop 0
    v_mfma_f32_16x16x32_bf16 v[32:35], v[108:111], v[52:55], v[32:35]
    buffer_load_dwordx4 v[68:71], v3, s[32:35], s62 offen offset:1024 nt
    v_and_b32 v48, v134, v4
    v_and_b32 v49, v134, v5
    v_and_b32_dpp v50, v134, v6 row_ror:8 row_mask:0xf bank_mask:0xf
    v_and_b32_dpp v51, v134, v7 row_ror:8 row_mask:0xf bank_mask:0xf
    s_waitcnt vmcnt(5)
    s_nop 0
    v_mfma_f32_16x16x32_bf16 v[32:35], v[112:115], v[48:51], v[32:35]
    buffer_load_dwordx4 v[72:75], v3, s[32:35], s62 offen offset:2048 nt
    v_fma_f32 v135, v135, s78, v39
    v_exp_f32 v135, v135
    s_nop 0
    v_add_f32 v37, v37, v135
    v_cvt_pk_bf16_f32 v135, v135, v135
    v_and_b32_dpp v52, v134, v4 row_ror:8 row_mask:0xf bank_mask:0xf
    v_and_b32_dpp v53, v134, v5 row_ror:8 row_mask:0xf bank_mask:0xf
    v_and_b32 v54, v134, v6
    v_and_b32 v55, v134, v7
    s_waitcnt vmcnt(5)
    s_nop 0
    v_mfma_f32_16x16x32_bf16 v[32:35], v[116:119], v[52:55], v[32:35]
    buffer_load_dwordx4 v[76:79], v3, s[32:35], s62 offen offset:3072 nt
    v_and_b32 v48, v135, v4
    v_and_b32 v49, v135, v5
    v_and_b32_dpp v50, v135, v6 row_ror:8 row_mask:0xf bank_mask:0xf
    v_and_b32_dpp v51, v135, v7 row_ror:8 row_mask:0xf bank_mask:0xf
    s_waitcnt vmcnt(5)
    s_nop 0
    v_mfma_f32_16x16x32_bf16 v[32:35], v[120:123], v[48:51], v[32:35]
    s_add_u32 s62, s60, 81920
    buffer_load_dwordx4 v[80:83], v3, s[32:35], s62 offen offset:0 nt
    v_fma_f32 v136, v136, s78, v39
    v_exp_f32 v136, v136
    s_nop 0
    v_add_f32 v37, v37, v136
    v_cvt_pk_bf16_f32 v136, v136, v136
    v_and_b32_dpp v52, v135, v4 row_ror:8 row_mask:0xf bank_mask:0xf
    v_and_b32_dpp v53, v135, v5 row_ror:8 row_mask:0xf bank_mask:0xf
    v_and_b32 v54, v135, v6
    v_and_b32 v55, v135, v7
    s_waitcnt vmcnt(5)
    s_nop 0
    v_mfma_f32_16x16x32_bf16 v[32:35], v[124:127], v[52:55], v[32:35]
    buffer_load_dwordx4 v[84:87], v3, s[32:35], s62 offen offset:1024 nt
    v_and_b32 v48, v136, v4
    v_and_b32 v49, v136, v5
    v_and_b32_dpp v50, v136, v6 row_ror:8 row_mask:0xf bank_mask:0xf
    v_and_b32_dpp v51, v136, v7 row_ror:8 row_mask:0xf bank_mask:0xf
    s_waitcnt vmcnt(5)
    s_nop 0
    v_mfma_f32_16x16x32_bf16 v[32:35], v[64:67], v[48:51], v[32:35]
    buffer_load_dwordx4 v[88:91], v3, s[32:35], s62 offen offset:2048 nt
    v_fma_f32 v137, v137, s78, v39
    v_exp_f32 v137, v137
    s_nop 0
    v_add_f32 v37, v37, v137
    v_cvt_pk_bf16_f32 v137, v137, v137
    v_and_b32_dpp v52, v136, v4 row_ror:8 row_mask:0xf bank_mask:0xf
    v_and_b32_dpp v53, v136, v5 row_ror:8 row_mask:0xf bank_mask:0xf
    v_and_b32 v54, v136, v6
    v_and_b32 v55, v136, v7
    s_waitcnt vmcnt(5)
    s_nop 0
    v_mfma_f32_16x16x32_bf16 v[32:35], v[68:71], v[52:55], v[32:35]
    buffer_load_dwordx4 v[92:95], v3, s[32:35], s62 offen offset:3072 nt
    v_and_b32 v48, v137, v4
    v_and_b32 v49, v137, v5
    v_and_b32_dpp v50, v137, v6 row_ror:8 row_mask:0xf bank_mask:0xf
    v_and_b32_dpp v51, v137, v7 row_ror:8 row_mask:0xf bank_mask:0xf
    s_waitcnt vmcnt(5)
    s_nop 0
    v_mfma_f32_16x16x32_bf16 v[32:35], v[72:75], v[48:51], v[32:35]
    s_add_u32 s62, s60, 98304
    buffer_load_dwordx4 v[96:99], v3, s[32:35], s62 offen offset:0 nt
    v_fma_f32 v138, v138, s78, v39
    v_exp_f32 v138, v138
    s_nop 0
    v_add_f32 v37, v37, v138
    v_cvt_pk_bf16_f32 v138, v138, v138
    v_and_b32_dpp v52, v137, v4 row_ror:8 row_mask:0xf bank_mask:0xf
    v_and_b32_dpp v53, v137, v5 row_ror:8 row_mask:0xf bank_mask:0xf
    v_and_b32 v54, v137, v6
    v_and_b32 v55, v137, v7
    s_waitcnt vmcnt(5)
    s_nop 0
    v_mfma_f32_16x16x32_bf16 v[32:35], v[76:79], v[52:55], v[32:35]
    buffer_load_dwordx4 v[100:103], v3, s[32:35], s62 offen offset:1024 nt
    v_and_b32 v48, v138, v4
    v_and_b32 v49, v138, v5
    v_and_b32_dpp v50, v138, v6 row_ror:8 row_mask:0xf bank_mask:0xf
    v_and_b32_dpp v51, v138, v7 row_ror:8 row_mask:0xf bank_mask:0xf
    s_waitcnt vmcnt(5)
    s_nop 0
    v_mfma_f32_16x16x32_bf16 v[32:35], v[80:83], v[48:51], v[32:35]
    buffer_load_dwordx4 v[104:107], v3, s[32:35], s62 offen offset:2048 nt
    v_fma_f32 v139, v139, s78, v39
    v_exp_f32 v139, v139
    s_nop 0
    v_add_f32 v37, v37, v139
    v_cvt_pk_bf16_f32 v139, v139, v139
    v_and_b32_dpp v52, v138, v4 row_ror:8 row_mask:0xf bank_mask:0xf
    v_and_b32_dpp v53, v138, v5 row_ror:8 row_mask:0xf bank_mask:0xf
    v_and_b32 v54, v138, v6
    v_and_b32 v55, v138, v7
    s_waitcnt vmcnt(5)
    s_nop 0
    v_mfma_f32_16x16x32_bf16 v[32:35], v[84:87], v[52:55], v[32:35]
    buffer_load_dwordx4 v[108:111], v3, s[32:35], s62 offen offset:3072 nt
    v_and_b32 v48, v139, v4
    v_and_b32 v49, v139, v5
    v_and_b32_dpp v50, v139, v6 row_ror:8 row_mask:0xf bank_mask:0xf
    v_and_b32_dpp v51, v139, v7 row_ror:8 row_mask:0xf bank_mask:0xf
    s_waitcnt vmcnt(5)
    s_nop 0
    v_mfma_f32_16x16x32_bf16 v[32:35], v[88:91], v[48:51], v[32:35]
    s_add_u32 s62, s60, 114688
    buffer_load_dwordx4 v[112:115], v3, s[32:35], s62 offen offset:0 nt
    v_fma_f32 v140, v140, s78, v39
    v_exp_f32 v140, v140
    s_nop 0
    v_add_f32 v37, v37, v140
    v_cvt_pk_bf16_f32 v140, v140, v140
    v_and_b32_dpp v52, v139, v4 row_ror:8 row_mask:0xf bank_mask:0xf
    v_and_b32_dpp v53, v139, v5 row_ror:8 row_mask:0xf bank_mask:0xf
    v_and_b32 v54, v139, v6
    v_and_b32 v55, v139, v7
    s_waitcnt vmcnt(5)
    s_nop 0
    v_mfma_f32_16x16x32_bf16 v[32:35], v[92:95], v[52:55], v[32:35]
    buffer_load_dwordx4 v[116:119], v3, s[32:35], s62 offen offset:1024 nt
    v_and_b32 v48, v140, v4
    v_and_b32 v49, v140, v5
    v_and_b32_dpp v50, v140, v6 row_ror:8 row_mask:0xf bank_mask:0xf
    v_and_b32_dpp v51, v140, v7 row_ror:8 row_mask:0xf bank_mask:0xf
    s_waitcnt vmcnt(5)
    s_nop 0
    v_mfma_f32_16x16x32_bf16 v[32:35], v[96:99], v[48:51], v[32:35]
    buffer_load_dwordx4 v[120:123], v3, s[32:35], s62 offen offset:2048 nt
    v_fma_f32 v141, v141, s78, v39
    v_exp_f32 v141, v141
    s_nop 0
    v_add_f32 v37, v37, v141
    v_cvt_pk_bf16_f32 v141, v141, v141
    v_and_b32_dpp v52, v140, v4 row_ror:8 row_mask:0xf bank_mask:0xf
    v_and_b32_dpp v53, v140, v5 row_ror:8 row_mask:0xf bank_mask:0xf
    v_and_b32 v54, v140, v6
    v_and_b32 v55, v140, v7
    s_waitcnt vmcnt(5)
    s_nop 0
    v_mfma_f32_16x16x32_bf16 v[32:35], v[100:103], v[52:55], v[32:35]
    buffer_load_dwordx4 v[124:127], v3, s[32:35], s62 offen offset:3072 nt
    v_and_b32 v48, v141, v4
    v_and_b32 v49, v141, v5
    v_and_b32_dpp v50, v141, v6 row_ror:8 row_mask:0xf bank_mask:0xf
    v_and_b32_dpp v51, v141, v7 row_ror:8 row_mask:0xf bank_mask:0xf
    s_waitcnt vmcnt(5)
    s_nop 0
    v_mfma_f32_16x16x32_bf16 v[32:35], v[104:107], v[48:51], v[32:35]
    buffer_load_dwordx4 v[64:67], v2, s[28:31], s61 offen offset:0 nt
    v_fma_f32 v142, v142, s78, v39
    v_exp_f32 v142, v142
    s_nop 0
    v_add_f32 v37, v37, v142
    v_cvt_pk_bf16_f32 v142, v142, v142
    v_and_b32_dpp v52, v141, v4 row_ror:8 row_mask:0xf bank_mask:0xf
    v_and_b32_dpp v53, v141, v5 row_ror:8 row_mask:0xf bank_mask:0xf
    v_and_b32 v54, v141, v6
    v_and_b32 v55, v141, v7
    s_waitcnt vmcnt(5)
    s_nop 0
    v_mfma_f32_16x16x32_bf16 v[32:35], v[108:111], v[52:55], v[32:35]
    buffer_load_dwordx4 v[68:71], v2, s[28:31], s61 offen offset:1024 nt
    v_and_b32 v48, v142, v4
    v_and_b32 v49, v142, v5
    v_and_b32_dpp v50, v142, v6 row_ror:8 row_mask:0xf bank_mask:0xf
    v_and_b32_dpp v51, v142, v7 row_ror:8 row_mask:0xf bank_mask:0xf
    s_waitcnt vmcnt(5)
    s_nop 0
    v_mfma_f32_16x16x32_bf16 v[32:35], v[112:115], v[48:51], v[32:35]
    buffer_load_dwordx4 v[72:75], v2, s[28:31], s61 offen offset:2048 nt
    v_fma_f32 v143, v143, s78, v39
    v_exp_f32 v143, v143
    s_nop 0
    v_add_f32 v37, v37, v143
    v_cvt_pk_bf16_f32 v143, v143, v143
    v_and_b32_dpp v52, v142, v4 row_ror:8 row_mask:0xf bank_mask:0xf
    v_and_b32_dpp v53, v142, v5 row_ror:8 row_mask:0xf bank_mask:0xf
    v_and_b32 v54, v142, v6
    v_and_b32 v55, v142, v7
    s_waitcnt vmcnt(5)
    s_nop 0
    v_mfma_f32_16x16x32_bf16 v[32:35], v[116:119], v[52:55], v[32:35]
    buffer_load_dwordx4 v[76:79], v2, s[28:31], s61 offen offset:3072 nt
    v_and_b32 v48, v143, v4
    v_and_b32 v49, v143, v5
    v_and_b32_dpp v50, v143, v6 row_ror:8 row_mask:0xf bank_mask:0xf
    v_and_b32_dpp v51, v143, v7 row_ror:8 row_mask:0xf bank_mask:0xf
    s_waitcnt vmcnt(5)
    s_nop 0
    v_mfma_f32_16x16x32_bf16 v[32:35], v[120:123], v[48:51], v[32:35]
    buffer_load_dwordx4 v[80:83], v57, s[84:87], s88 offen offset:0 nt
    v_and_b32_dpp v52, v143, v4 row_ror:8 row_mask:0xf bank_mask:0xf
    v_and_b32_dpp v53, v143, v5 row_ror:8 row_mask:0xf bank_mask:0xf
    v_and_b32 v54, v143, v6
    v_and_b32 v55, v143, v7
    s_waitcnt vmcnt(5)
    s_nop 0
    v_mfma_f32_16x16x32_bf16 v[32:35], v[124:127], v[52:55], v[32:35]
    buffer_load_dwordx4 v[84:87], v57, s[84:87], s88 offen offset:1024 nt
    s_mov_b32 s60, s61
    s_sub_u32 s63, s63, 1
    s_cmp_eq_u32 s63, 0
    s_cbranch_scc1 L_small_entry
    s_add_u32 s61, s60, 131072
    s_add_u32 s88, s60, 147456
    s_cmp_gt_u32 s63, 1
    s_cselect_b64 s[74:75], -1, 0
    s_cselect_b32 s84, s28, s32
    s_cselect_b32 s85, s29, s33
    s_cselect_b32 s88, s88, s61
    v_cndmask_b32 v57, v3, v2, s[74:75]
    s_add_u32 s65, s63, s64
    s_cmp_gt_u32 s65, 1
    s_cselect_b32 s61, s61, 0x80000000
    s_cselect_b32 s88, s88, 0x80000000
    s_branch L_big
L_small_entry:
    s_cmp_eq_u32 s64, 0
    s_cbranch_scc1 L_stream_done
    buffer_load_dwordx4 v[88:91], v3, s[32:35], s60 offen offset:2048 nt
    buffer_load_dwordx4 v[92:95], v3, s[32:35], s60 offen offset:3072 nt
    s_mov_b32 s14, 163140
    s_mov_b32 s58, 163148
    s_mov_b32 s63, 0
    s_lshl_b32 s66, s56, 12
    v_min_u32 v57, 3, v1
.p2align 6
L_small:
    v_mov_b32 v48, s14
    s_cmp_lg_u32 s56, 0
    s_cbranch_scc1 L_mb_read
    s_cmp_lg_u32 s63, 1
    s_cbranch_scc1 L_mb_idle
    s_waitcnt lgkmcnt(0)
    s_lshr_b32 s67, s3, 3
    s_add_u32 s65, s67, 59
    s_mov_b32 s68, 1
    s_lshl_b32 s69, s67, 1
    s_add_u32 s69, s69, 55
    s_cmp_lt_u32 s67, 4
    s_cselect_b32 s65, s69, s65
    s_cselect_b32 s68, 2, s68
    s_lshl_b32 s69, s67, 2
    s_add_u32 s69, s69, 51
    s_cmp_lt_u32 s67, 2
    s_cselect_b32 s65, s69, s65
    s_cselect_b32 s68, 4, s68
    s_and_b32 s69, s3, 7
    s_lshl_b32 s69, s69, 6
    s_add_u32 s65, s65, s69
    s_cmp_lt_u32 s67, 5
    s_cselect_b32 s65, s65, 0x20000
    s_cselect_b32 s63, 0, 2
    v_add_u32 v50, s65, v57
    v_cmp_gt_u32 vcc, s68, v57
    v_lshl_add_u32 v51, v57, 2, s58
    s_nop 0
    v_cndmask_b32 v50, -1, v50, vcc
    s_lshl_b32 s68, s68, 2
    s_add_u32 s58, s58, s68
    ds_write_b32 v51, v50
L_mb_idle:
    ds_read_b32 v49, v48
    s_add_u32 s65, s14, 8
    s_cmp_gt_u32 s58, s65
    s_cbranch_scc1 L_mb_wait
    s_cmp_lg_u32 s63, 0
    s_cbranch_scc1 L_mb_wait
    s_waitcnt lgkmcnt(0)
    s_mov_b32 s63, 1
    s_mov_b32 s3, 1
    s_atomic_add s3, s[24:25], 0 glc
    s_branch L_mb_got
L_mb_read:
    ds_read_b32 v49, v48
L_mb_wait:
    s_waitcnt lgkmcnt(0)
L_mb_got:
    v_readfirstlane_b32 s64, v49
    s_cmp_lg_u32 s64, -1
    s_cbranch_scc1 L_mb_ok
    s_sub_u32 s73, s73, 1
    s_cbranch_scc0 L_mb_read
    s_mov_b32 s64, 0x20000
    s_mov_b32 s73, 0
L_mb_ok:
    s_lshl_b32 s61, s64, 14
    s_add_u32 s61, s61, s66
    s_add_u32 s14, s14, 4
    s_waitcnt vmcnt(7)
    v_mfma_f32_16x16x32_bf16 v[16:19], v[64:67], v[8:11], 0
    buffer_load_dwordx4 v[64:67], v2, s[28:31], s61 offen offset:0 nt
    s_waitcnt vmcnt(7)
    v_mfma_f32_16x16x32_bf16 v[16:19], v[68:71], v[12:15], v[16:19]
    buffer_load_dwordx4 v[68:71], v2, s[28:31], s61 offen offset:1024 nt
    s_waitcnt vmcnt(7)
    v_mfma_f32_16x16x32_bf16 v[20:23], v[72:75], v[8:11], 0
    buffer_load_dwordx4 v[72:75], v2, s[28:31], s61 offen offset:2048 nt
    s_waitcnt vmcnt(7)
    v_mfma_f32_16x16x32_bf16 v[20:23], v[76:79], v[12:15], v[20:23]
    buffer_load_dwordx4 v[76:79], v2, s[28:31], s61 offen offset:3072 nt
    s_nop 0
    v_mov_b32_dpp v128, v16 quad_perm:[0,0,0,0] row_mask:0xf bank_mask:0xf
    v_add_f32_dpp v128, v17, v128 quad_perm:[1,1,1,1] row_mask:0xf bank_mask:0xf
    v_add_f32_dpp v128, v18, v128 quad_perm:[2,2,2,2] row_mask:0xf bank_mask:0xf
    v_add_f32_dpp v128, v19, v128 quad_perm:[3,3,3,3] row_mask:0xf bank_mask:0xf
    s_nop 1
    v_mov_b32_dpp v129, v20 quad_perm:[0,0,0,0] row_mask:0xf bank_mask:0xf
    v_add_f32_dpp v129, v21, v129 quad_perm:[1,1,1,1] row_mask:0xf bank_mask:0xf
    v_add_f32_dpp v129, v22, v129 quad_perm:[2,2,2,2] row_mask:0xf bank_mask:0xf
    v_add_f32_dpp v129, v23, v129 quad_perm:[3,3,3,3] row_mask:0xf bank_mask:0xf
    v_cvt_pk_bf16_f32 v41, v128, v129
    v_lshlrev_b32 v128, 16, v41
    v_and_b32 v129, s76, v41
    v_mul_f32 v128, s77, v128
    v_mul_f32 v129, s77, v129
    v_cvt_pk_bf16_f32 v41, v128, v129
    v_lshlrev_b32 v128, 16, v41
    v_and_b32 v129, s76, v41
    v_max3_f32 v40, v36, v128, v129
    s_nop 1
    v_max_f32_dpp v40, v40, v40 row_ror:8 row_mask:0xf bank_mask:0xf
    v_mov_b32 v41, v40
    s_nop 1
    v_permlane16_swap_b32 v40, v41
    v_max_f32 v40, v40, v41
    v_mov_b32 v41, v40
    s_nop 1
    v_permlane32_swap_b32 v40, v41
    v_max_f32 v40, v40, v41
    v_sub_f32 v38, v36, v40
    v_mul_f32 v39, s78, v40
    v_mul_f32 v38, s78, v38
    v_sub_f32 v39, 0, v39
    v_exp_f32 v38, v38
    v_mov_b32 v36, v40
    v_mul_f32 v37, v37, v38
    v_fma_f32 v128, v128, s78, v39
    v_exp_f32 v128, v128
    s_nop 0
    v_add_f32 v37, v37, v128
    v_cvt_pk_bf16_f32 v128, v128, v128
    v_mul_f32 v32, v32, v38
    v_mul_f32 v33, v33, v38
    v_mul_f32 v34, v34, v38
    v_mul_f32 v35, v35, v38
    v_and_b32 v48, v128, v4
    v_and_b32 v49, v128, v5
    v_and_b32_dpp v50, v128, v6 row_ror:8 row_mask:0xf bank_mask:0xf
    v_and_b32_dpp v51, v128, v7 row_ror:8 row_mask:0xf bank_mask:0xf
    s_waitcnt vmcnt(7)
    s_nop 0
    v_mfma_f32_16x16x32_bf16 v[32:35], v[80:83], v[48:51], v[32:35]
    buffer_load_dwordx4 v[80:83], v3, s[32:35], s61 offen offset:0 nt
    v_fma_f32 v129, v129, s78, v39
    v_exp_f32 v129, v129
    s_nop 0
    v_add_f32 v37, v37, v129
    v_cvt_pk_bf16_f32 v129, v129, v129
    v_and_b32_dpp v52, v128, v4 row_ror:8 row_mask:0xf bank_mask:0xf
    v_and_b32_dpp v53, v128, v5 row_ror:8 row_mask:0xf bank_mask:0xf
    v_and_b32 v54, v128, v6
    v_and_b32 v55, v128, v7
    s_waitcnt vmcnt(7)
    s_nop 0
    v_mfma_f32_16x16x32_bf16 v[32:35], v[84:87], v[52:55], v[32:35]
    buffer_load_dwordx4 v[84:87], v3, s[32:35], s61 offen offset:1024 nt
    v_and_b32 v48, v129, v4
    v_and_b32 v49, v129, v5
    v_and_b32_dpp v50, v129, v6 row_ror:8 row_mask:0xf bank_mask:0xf
    v_and_b32_dpp v51, v129, v7 row_ror:8 row_mask:0xf bank_mask:0xf
    s_waitcnt vmcnt(7)
    s_nop 0
    v_mfma_f32_16x16x32_bf16 v[32:35], v[88:91], v[48:51], v[32:35]
    buffer_load_dwordx4 v[88:91], v3, s[32:35], s61 offen offset:2048 nt
    v_and_b32_dpp v52, v129, v4 row_ror:8 row_mask:0xf bank_mask:0xf
    v_and_b32_dpp v53, v129, v5 row_ror:8 row_mask:0xf bank_mask:0xf
    v_and_b32 v54, v129, v6
    v_and_b32 v55, v129, v7
    s_waitcnt vmcnt(7)
    s_nop 0
    v_mfma_f32_16x16x32_bf16 v[32:35], v[92:95], v[52:55], v[32:35]
    buffer_load_dwordx4 v[92:95], v3, s[32:35], s61 offen offset:3072 nt
    s_mov_b32 s60, s61
    s_cmp_lt_u32 s64, 512
    s_cbranch_scc0 L_stream_done
    s_cmp_lt_u32 s14, 163808
    s_cbranch_scc1 L_small
L_stream_done:
    s_nop 3
    ds_write_b128 v252, v[32:35]
    v_add_f32_dpp v37, v37, v37 row_ror:8 row_mask:0xf bank_mask:0xf
    v_mov_b32 v41, v37
    s_nop 1
    v_permlane16_swap_b32 v37, v41
    v_add_f32 v37, v37, v41
    v_mov_b32 v41, v37
    s_nop 1
    v_permlane32_swap_b32 v37, v41
    v_add_f32 v37, v37, v41
    ds_write_b64 v253, v[36:37]
    s_waitcnt lgkmcnt(0)
    s_barrier
    s_cmp_lg_u32 s56, 0
    s_cbranch_scc1 L_dispatch
    ds_read_b64 v[148:149], v253 offset:0
    ds_read_b64 v[150:151], v253 offset:512
    ds_read_b64 v[152:153], v253 offset:1024
    ds_read_b64 v[154:155], v253 offset:1536
    ds_read_b128 v[132:135], v252 offset:0
    ds_read_b128 v[136:139], v252 offset:1024
    ds_read_b128 v[140:143], v252 offset:2048
    ds_read_b128 v[144:147], v252 offset:3072
    s_waitcnt lgkmcnt(4)
    v_max3_f32 v164, v148, v150, v152
    v_max_f32 v164, v164, v154
    v_mul_f32 v166, s78, v164
    v_fma_f32 v156, v148, s78, -v166
    v_fma_f32 v157, v150, s78, -v166
    v_fma_f32 v158, v152, s78, -v166
    v_fma_f32 v159, v154, s78, -v166
    v_exp_f32 v156, v156
    v_exp_f32 v157, v157
    v_exp_f32 v158, v158
    v_exp_f32 v159, v159
    s_waitcnt lgkmcnt(3)
    v_pk_mul_f32 v[160:161], v[132:133], v[156:157] op_sel_hi:[1,0]
    v_pk_mul_f32 v[162:163], v[134:135], v[156:157] op_sel_hi:[1,0]
    s_waitcnt lgkmcnt(2)
    v_pk_fma_f32 v[160:161], v[136:137], v[156:157], v[160:161] op_sel:[0,1,0] op_sel_hi:[1,1,1]
    v_pk_fma_f32 v[162:163], v[138:139], v[156:157], v[162:163] op_sel:[0,1,0] op_sel_hi:[1,1,1]
    s_waitcnt lgkmcnt(1)
    v_pk_fma_f32 v[160:161], v[140:141], v[158:159], v[160:161] op_sel_hi:[1,0,1]
    v_pk_fma_f32 v[162:163], v[142:143], v[158:159], v[162:163] op_sel_hi:[1,0,1]
    s_waitcnt lgkmcnt(0)
    v_pk_fma_f32 v[160:161], v[144:145], v[158:159], v[160:161] op_sel:[0,1,0] op_sel_hi:[1,1,1]
    v_pk_fma_f32 v[162:163], v[146:147], v[158:159], v[162:163] op_sel:[0,1,0] op_sel_hi:[1,1,1]
    v_bfi_b32 v160, s79, v56, v160
    buffer_store_dwordx4 v[160:163], v254, s[36:39], s15 offen sc1
    v_mul_f32 v165, v156, v149
    v_fmac_f32 v165, v157, v151
    v_fmac_f32 v165, v158, v153
    v_fmac_f32 v165, v159, v155
    v_bfi_b32 v164, s79, v56, v164
    v_bfi_b32 v165, s79, v56, v165
    v_mov_b32 v166, v164
    v_mov_b32 v167, v165
    buffer_store_dwordx4 v[164:167], v255, s[36:39], s15 offen sc1
L_dispatch:
    s_cmp_eq_u32 s70, 2
    s_cbranch_scc1 L_tail_ffn
    s_cmp_eq_u32 s70, 0
    s_cbranch_scc1 L_tail_plain
    v_lshrrev_b32 v41, 5, v1
    v_mul_u32_u24 v44, 163840, v41
    v_and_b32 v42, 31, v1
    v_lshl_add_u32 v128, v42, 4, v44
    v_and_b32 v43, 7, v1
    v_mad_u32_u24 v129, v43, s0, v44
    v_mul_u32_u24 v41, 2176, v41
    v_lshl_add_u32 v41, v42, 2, v41
    s_lshl_b32 s65, s56, 7
    s_add_u32 s65, s65, 73728
    v_add_u32 v130, s65, v41
    v_and_b32 v41, 3, v1
    v_mul_u32_u24 v41, 1088, v41
    v_lshl_add_u32 v41, v58, 4, v41
    v_add_u32 v131, 73728, v41
    v_and_b32 v41, 1, v58
    v_mul_u32_u24 v41, 2304, v41
    v_and_b32 v42, 12, v1
    v_lshl_add_u32 v42, v42, 2, v41
    v_and_b32 v41, 0x23, v1
    v_cmp_eq_u32 vcc, 0, v41
    v_mov_b32 v43, 0x80000000
    s_nop 0
    v_cndmask_b32 v132, v43, v42, vcc
    v_and_b32 v41, 1, v1
    v_mul_u32_u24 v41, 0xaaaa, v41
    v_add_u32 v55, 0x4444, v41
    v_and_b32 v41, 16, v1
    v_cmp_ne_u32 s[74:75], 0, v41
    v_mov_b32 v64, 0
    v_mov_b32 v65, 0
    v_mov_b32 v66, 0
    v_mov_b32 v67, 0
    s_lshl_b32 s65, s71, 1
    s_lshr_b32 s66, s56, 1
    s_add_u32 s65, s65, s66
    s_and_b32 s66, s56, 1
    s_mul_i32 s67, s65, 10240
    s_add_u32 s67, s67, 196608
    s_lshl_b32 s68, s66, 4
    s_add_u32 s65, s67, s68
    s_lshl_b32 s68, s66, 9
    s_add_u32 s67, s67, s68
    s_add_u32 s68, s67, 3840
    s_add_u32 s69, s67, 7680
    s_lshl_b32 s61, s66, 4
    s_sub_u32 s61, s65, s61
    s_mul_i32 s66, s71, 4608
    s_lshl_b32 s62, s72, 8
    s_add_u32 s66, s66, s62
    s_lshl_b32 s62, s56, 6
    s_add_u32 s66, s66, s62
    s_add_u32 s66, s66, 524288
    s_lshl_b32 s62, s71, 3
    s_add_u32 s62, s62, s71
    s_add_u32 s62, s62, s72
    s_lshl_b32 s62, s62, 7
    s_add_u32 s62, s62, 147456
    s_lshl_b32 s62, s71, 8
    s_lshl_b32 s60, s56, 6
    s_add_u32 s62, s62, s60
    s_add_u32 s62, s62, 147456
    s_and_b32 s60, s56, 1
    s_or_b32 s60, s60, s72
    v_or_b32 v41, s60, v1
    v_cmp_eq_u32 vcc, 0, v41
    s_nop 1
    v_cndmask_b32 v133, v43, v41, vcc
L_oagain:
    buffer_load_dwordx4 v[168:171], v129, s[36:39], s65 offen offset:1024 sc1
    buffer_load_dwordx4 v[136:139], v128, s[36:39], s67 offen offset:0 sc1
    buffer_load_dwordx4 v[140:143], v128, s[36:39], s67 offen offset:1280 sc1
    buffer_load_dwordx4 v[144:147], v128, s[36:39], s67 offen offset:2560 sc1
    buffer_load_dwordx4 v[148:151], v128, s[36:39], s68 offen offset:0 sc1
    buffer_load_dwordx4 v[152:155], v128, s[36:39], s68 offen offset:1280 sc1
    buffer_load_dwordx4 v[156:159], v128, s[36:39], s68 offen offset:2560 sc1
    buffer_load_dwordx4 v[160:163], v128, s[36:39], s69 offen offset:0 sc1
    buffer_load_dwordx4 v[164:167], v128, s[36:39], s69 offen offset:1280 sc1
    s_waitcnt vmcnt(8)
    v_xor_b32 v168, v168, v56
    v_xor_b32 v169, v169, v56
    v_xor_b32 v170, v170, v56
    v_xor_b32 v171, v171, v56
    v_max_f32_dpp v43, v168, v168 quad_perm:[1,0,3,2] row_mask:0xf bank_mask:0xf
    v_or3_b32 v41, v168, v169, v170
    v_or_b32 v41, v41, v171
    v_max_f32_dpp v43, v43, v43 quad_perm:[2,3,0,1] row_mask:0xf bank_mask:0xf
    s_nop 1
    v_max_f32_dpp v43, v43, v43 row_half_mirror row_mask:0xf bank_mask:0xf
    v_sub_f32 v44, v168, v43
    v_mul_f32 v44, s78, v44
    v_exp_f32 v44, v44
    s_nop 0
    v_mul_f32 v45, v44, v169
    s_nop 1
    v_add_f32_dpp v45, v45, v45 quad_perm:[1,0,3,2] row_mask:0xf bank_mask:0xf
    s_nop 1
    v_add_f32_dpp v45, v45, v45 quad_perm:[2,3,0,1] row_mask:0xf bank_mask:0xf
    s_nop 1
    v_add_f32_dpp v45, v45, v45 row_half_mirror row_mask:0xf bank_mask:0xf
    v_rcp_f32 v45, v45
    s_waitcnt vmcnt(7)
    v_xor_b32 v136, v136, v56
    v_mul_f32_dpp v173, v44, v137 row_newbcast:0 row_mask:0xf bank_mask:0xf
    v_mul_f32_dpp v174, v44, v138 row_newbcast:0 row_mask:0xf bank_mask:0xf
    v_mul_f32_dpp v175, v44, v139 row_newbcast:0 row_mask:0xf bank_mask:0xf
    v_mul_f32_dpp v172, v44, v136 row_newbcast:0 row_mask:0xf bank_mask:0xf
    v_or_b32 v41, v41, v136
    s_waitcnt vmcnt(6)
    v_xor_b32 v140, v140, v56
    v_fmac_f32_dpp v173, v44, v141 row_newbcast:1 row_mask:0xf bank_mask:0xf
    v_fmac_f32_dpp v174, v44, v142 row_newbcast:1 row_mask:0xf bank_mask:0xf
    v_fmac_f32_dpp v175, v44, v143 row_newbcast:1 row_mask:0xf bank_mask:0xf
    v_fmac_f32_dpp v172, v44, v140 row_newbcast:1 row_mask:0xf bank_mask:0xf
    v_or_b32 v41, v41, v140
    s_waitcnt vmcnt(5)
    v_xor_b32 v144, v144, v56
    v_fmac_f32_dpp v173, v44, v145 row_newbcast:2 row_mask:0xf bank_mask:0xf
    v_fmac_f32_dpp v174, v44, v146 row_newbcast:2 row_mask:0xf bank_mask:0xf
    v_fmac_f32_dpp v175, v44, v147 row_newbcast:2 row_mask:0xf bank_mask:0xf
    v_fmac_f32_dpp v172, v44, v144 row_newbcast:2 row_mask:0xf bank_mask:0xf
    v_or_b32 v41, v41, v144
    s_waitcnt vmcnt(4)
    v_xor_b32 v148, v148, v56
    v_fmac_f32_dpp v173, v44, v149 row_newbcast:3 row_mask:0xf bank_mask:0xf
    v_fmac_f32_dpp v174, v44, v150 row_newbcast:3 row_mask:0xf bank_mask:0xf
    v_fmac_f32_dpp v175, v44, v151 row_newbcast:3 row_mask:0xf bank_mask:0xf
    v_fmac_f32_dpp v172, v44, v148 row_newbcast:3 row_mask:0xf bank_mask:0xf
    v_or_b32 v41, v41, v148
    s_waitcnt vmcnt(3)
    v_xor_b32 v152, v152, v56
    v_fmac_f32_dpp v173, v44, v153 row_newbcast:4 row_mask:0xf bank_mask:0xf
    v_fmac_f32_dpp v174, v44, v154 row_newbcast:4 row_mask:0xf bank_mask:0xf
    v_fmac_f32_dpp v175, v44, v155 row_newbcast:4 row_mask:0xf bank_mask:0xf
    v_fmac_f32_dpp v172, v44, v152 row_newbcast:4 row_mask:0xf bank_mask:0xf
    v_or_b32 v41, v41, v152
    s_waitcnt vmcnt(2)
    v_xor_b32 v156, v156, v56
    v_fmac_f32_dpp v173, v44, v157 row_newbcast:5 row_mask:0xf bank_mask:0xf
    v_fmac_f32_dpp v174, v44, v158 row_newbcast:5 row_mask:0xf bank_mask:0xf
    v_fmac_f32_dpp v175, v44, v159 row_newbcast:5 row_mask:0xf bank_mask:0xf
    v_fmac_f32_dpp v172, v44, v156 row_newbcast:5 row_mask:0xf bank_mask:0xf
    v_or_b32 v41, v41, v156
    s_waitcnt vmcnt(1)
    v_xor_b32 v160, v160, v56
    v_fmac_f32_dpp v173, v44, v161 row_newbcast:6 row_mask:0xf bank_mask:0xf
    v_fmac_f32_dpp v174, v44, v162 row_newbcast:6 row_mask:0xf bank_mask:0xf
    v_fmac_f32_dpp v175, v44, v163 row_newbcast:6 row_mask:0xf bank_mask:0xf
    v_fmac_f32_dpp v172, v44, v160 row_newbcast:6 row_mask:0xf bank_mask:0xf
    v_or_b32 v41, v41, v160
    s_waitcnt vmcnt(0)
    v_xor_b32 v164, v164, v56
    v_fmac_f32_dpp v173, v44, v165 row_newbcast:7 row_mask:0xf bank_mask:0xf
    v_fmac_f32_dpp v174, v44, v166 row_newbcast:7 row_mask:0xf bank_mask:0xf
    v_fmac_f32_dpp v175, v44, v167 row_newbcast:7 row_mask:0xf bank_mask:0xf
    v_fmac_f32_dpp v172, v44, v164 row_newbcast:7 row_mask:0xf bank_mask:0xf
    v_or_b32 v41, v41, v164
    v_and_b32 v41, s79, v41
    v_cmp_ne_u32 vcc, 0, v41
    s_cbranch_vccz L_od_3
    s_sub_u32 s73, s73, 1
    s_cbranch_scc0 L_oagain
    s_mov_b32 s73, 0
L_od_3:
    buffer_store_dword v56, v133, s[36:39], s62 offen sc1
    v_mul_f32 v172, v172, v45
    v_mul_f32 v173, v173, v45
    v_mul_f32 v174, v174, v45
    v_mul_f32 v175, v175, v45
    v_cvt_pk_bf16_f32 v172, v172, v173
    v_cvt_pk_bf16_f32 v173, v174, v175
    ds_write_b32 v130, v172
    ds_write_b32 v130, v173 offset:1088
    s_waitcnt lgkmcnt(0)
    s_barrier
    ds_read_b128 v[176:179], v131 offset:0
    ds_read_b128 v[180:183], v131 offset:64
    ds_read_b128 v[184:187], v131 offset:128
    ds_read_b128 v[188:191], v131 offset:192
    ds_read_b128 v[192:195], v131 offset:256
    ds_read_b128 v[196:199], v131 offset:320
    ds_read_b128 v[200:203], v131 offset:384
    ds_read_b128 v[204:207], v131 offset:448
    s_waitcnt lgkmcnt(7)
    v_smfmac_f32_16x16x64_bf16 v[64:67], v[176:179], a[0:7], v55
    s_waitcnt lgkmcnt(6)
    v_smfmac_f32_16x16x64_bf16 v[64:67], v[180:183], a[8:15], v55
    s_waitcnt lgkmcnt(5)
    v_smfmac_f32_16x16x64_bf16 v[64:67], v[184:187], a[16:23], v55
    s_waitcnt lgkmcnt(4)
    v_smfmac_f32_16x16x64_bf16 v[64:67], v[188:191], a[24:31], v55
    s_waitcnt lgkmcnt(3)
    v_smfmac_f32_16x16x64_bf16 v[64:67], v[192:195], a[32:39], v55
    s_waitcnt lgkmcnt(2)
    v_smfmac_f32_16x16x64_bf16 v[64:67], v[196:199], a[40:47], v55
    s_waitcnt lgkmcnt(1)
    v_smfmac_f32_16x16x64_bf16 v[64:67], v[200:203], a[48:55], v55
    s_waitcnt lgkmcnt(0)
    v_smfmac_f32_16x16x64_bf16 v[64:67], v[204:207], a[56:63], v55
    s_nop 7
    v_add_f32 v64, v64, v65
    v_add_f32 v66, v66, v67
    v_cndmask_b32 v64, v64, v66, s[74:75]
    s_nop 1
    v_mov_b32_dpp v172, v64 quad_perm:[0,0,0,0] row_mask:0xf bank_mask:0xf
    v_mov_b32_dpp v173, v64 quad_perm:[1,1,1,1] row_mask:0xf bank_mask:0xf
    v_mov_b32_dpp v174, v64 quad_perm:[2,2,2,2] row_mask:0xf bank_mask:0xf
    v_mov_b32_dpp v175, v64 quad_perm:[3,3,3,3] row_mask:0xf bank_mask:0xf
    v_bfi_b32 v172, s79, v56, v172
    buffer_store_dwordx4 v[172:175], v132, s[36:39], s66 offen sc1
    s_branch L_finish
L_tail_ffn:
    s_mov_b32 s48, s4
    s_mov_b32 s49, s5
    s_mov_b32 s50, 2304
    s_mov_b32 s51, 0x20000
    v_cmp_gt_u32 vcc, 16, v1
    v_lshlrev_b32 v41, 3, v1
    v_add_u32 v42, 1024, v41
    v_mov_b32 v43, 0x80000000
    v_cndmask_b32 v42, v43, v42, vcc
    s_mul_i32 s65, s56, 1152
    buffer_load_dwordx2 v[144:145], v41, s[48:51], s65 offen
    buffer_load_dwordx2 v[146:147], v41, s[48:51], s65 offen offset:512
    buffer_load_dwordx2 v[148:149], v42, s[48:51], s65 offen
    s_mov_b32 s40, s18
    s_mov_b32 s41, s19
    s_mov_b32 s42, 5308416
    s_mov_b32 s43, 0x20000
    v_lshrrev_b32 v41, 3, v1
    v_mul_u32_u24 v41, 9216, v41
    v_and_b32 v42, 7, v1
    v_lshl_add_u32 v129, v42, 4, v41
    s_mul_i32 s67, s56, 73728
    s_lshl_b32 s68, s71, 7
    s_add_u32 s67, s67, s68
    s_lshl_b32 s69, s56, 10
    s_add_u32 s62, s67, 3538944
    s_add_u32 m0, s69, 122880
    s_nop 0
    buffer_load_dwordx4 v129, s[40:43], s62 offen  lds
    s_add_u32 s62, s67, 3833856
    s_add_u32 m0, s69, 126976
    s_nop 0
    buffer_load_dwordx4 v129, s[40:43], s62 offen  lds
    s_add_u32 s62, s67, 4128768
    s_add_u32 m0, s69, 131072
    s_nop 0
    buffer_load_dwordx4 v129, s[40:43], s62 offen  lds
    s_add_u32 s62, s67, 4423680
    s_add_u32 m0, s69, 135168
    s_nop 0
    buffer_load_dwordx4 v129, s[40:43], s62 offen  lds
    s_add_u32 s62, s67, 4718592
    s_add_u32 m0, s69, 139264
    s_nop 0
    buffer_load_dwordx4 v129, s[40:43], s62 offen  lds
    s_add_u32 s62, s67, 5013504
    s_add_u32 m0, s69, 143360
    s_nop 0
    buffer_load_dwordx4 v129, s[40:43], s62 offen  lds
    s_mul_i32 s67, s71, 73728
    s_add_u32 s44, s20, s67
    s_addc_u32 s45, s21, 0
    s_mov_b32 s46, 73728
    s_mov_b32 s47, 0x20000
    s_lshl_b32 s69, s56, 10
    s_add_u32 s62, s69, 0
    s_add_u32 m0, s69, 0
    s_nop 0
    buffer_load_dwordx4 v3, s[44:47], s62 offen  lds
    s_add_u32 s62, s69, 4096
    s_add_u32 m0, s69, 4096
    s_nop 0
    buffer_load_dwordx4 v3, s[44:47], s62 offen  lds
    s_add_u32 s62, s69, 8192
    s_add_u32 m0, s69, 8192
    s_nop 0
    buffer_load_dwordx4 v3, s[44:47], s62 offen  lds
    s_add_u32 s62, s69, 12288
    s_add_u32 m0, s69, 12288
    s_nop 0
    buffer_load_dwordx4 v3, s[44:47], s62 offen  lds
    s_add_u32 s62, s69, 16384
    s_add_u32 m0, s69, 16384
    s_nop 0
    buffer_load_dwordx4 v3, s[44:47], s62 offen  lds
    s_add_u32 s62, s69, 20480
    s_add_u32 m0, s69, 20480
    s_nop 0
    buffer_load_dwordx4 v3, s[44:47], s62 offen  lds
    s_add_u32 s62, s69, 24576
    s_add_u32 m0, s69, 24576
    s_nop 0
    buffer_load_dwordx4 v3, s[44:47], s62 offen  lds
    s_add_u32 s62, s69, 28672
    s_add_u32 m0, s69, 28672
    s_nop 0
    buffer_load_dwordx4 v3, s[44:47], s62 offen  lds
    s_add_u32 s62, s69, 32768
    s_add_u32 m0, s69, 32768
    s_nop 0
    buffer_load_dwordx4 v3, s[44:47], s62 offen  lds
    s_add_u32 s62, s69, 36864
    s_add_u32 m0, s69, 36864
    s_nop 0
    buffer_load_dwordx4 v3, s[44:47], s62 offen  lds
    s_add_u32 s62, s69, 40960
    s_add_u32 m0, s69, 40960
    s_nop 0
    buffer_load_dwordx4 v3, s[44:47], s62 offen  lds
    s_add_u32 s62, s69, 45056
    s_add_u32 m0, s69, 45056
    s_nop 0
    buffer_load_dwordx4 v3, s[44:47], s62 offen  lds
    s_add_u32 s62, s69, 49152
    s_add_u32 m0, s69, 49152
    s_nop 0
    buffer_load_dwordx4 v3, s[44:47], s62 offen  lds
    s_add_u32 s62, s69, 53248
    s_add_u32 m0, s69, 53248
    s_nop 0
    buffer_load_dwordx4 v3, s[44:47], s62 offen  lds
    s_add_u32 s62, s69, 57344
    s_add_u32 m0, s69, 57344
    s_nop 0
    buffer_load_dwordx4 v3, s[44:47], s62 offen  lds
    s_add_u32 s62, s69, 61440
    s_add_u32 m0, s69, 61440
    s_nop 0
    buffer_load_dwordx4 v3, s[44:47], s62 offen  lds
    s_add_u32 s62, s69, 65536
    s_add_u32 m0, s69, 65536
    s_nop 0
    buffer_load_dwordx4 v3, s[44:47], s62 offen  lds
    s_add_u32 s62, s69, 69632
    s_add_u32 m0, s69, 69632
    s_nop 0
    buffer_load_dwordx4 v3, s[44:47], s62 offen  lds
    v_and_b32 v41, 3, v1
    v_mul_u32_u24 v42, 576, v41
    v_lshl_add_u32 v42, v58, 4, v42
    v_add_u32 v240, 147456, v42
    v_lshlrev_b32 v42, 6, v41
    v_lshl_add_u32 v42, v58, 4, v42
    v_add_u32 v241, 162880, v42
    v_and_b32 v41, 1, v58
    v_lshlrev_b32 v41, 7, v41
    v_bfe_u32 v42, v1, 1, 1
    v_lshl_add_u32 v41, v42, 6, v41
    v_and_b32 v42, 12, v1
    v_add_u32 v41, v41, v42
    v_and_b32 v42, 1, v1
    v_lshl_add_u32 v41, v42, 1, v41
    s_lshl_b32 s65, s56, 4
    s_add_u32 s65, s65, 162880
    v_add_u32 v242, s65, v41
    v_and_b32 v41, 1, v1
    v_mul_u32_u24 v41, 0xaaaa, v41
    v_add_u32 v55, 0x4444, v41
    v_mov_b32 v64, 0
    v_mov_b32 v65, 0
    v_mov_b32 v66, 0
    v_mov_b32 v67, 0
    v_mov_b32 v68, 0
    v_mov_b32 v69, 0
    v_mov_b32 v70, 0
    v_mov_b32 v71, 0
    v_mov_b32 v72, 0
    v_mov_b32 v73, 0
    v_mov_b32 v74, 0
    v_mov_b32 v75, 0
    v_mov_b32 v76, 0
    v_mov_b32 v77, 0
    v_mov_b32 v78, 0
    v_mov_b32 v79, 0
    v_mov_b32 v80, 0
    v_mov_b32 v81, 0
    v_mov_b32 v82, 0
    v_mov_b32 v83, 0
    v_mov_b32 v84, 0
    v_mov_b32 v85, 0
    v_mov_b32 v86, 0
    v_mov_b32 v87, 0
    v_mov_b32 v88, 0
    v_mov_b32 v89, 0
    v_mov_b32 v90, 0
    v_mov_b32 v91, 0
    v_mov_b32 v92, 0
    v_mov_b32 v93, 0
    v_mov_b32 v94, 0
    v_mov_b32 v95, 0
    v_mov_b32 v96, 0
    v_mov_b32 v97, 0
    v_mov_b32 v98, 0
    v_mov_b32 v99, 0
    v_mov_b32 v100, 0
    v_mov_b32 v101, 0
    v_mov_b32 v102, 0
    v_mov_b32 v103, 0
    v_mov_b32 v104, 0
    v_mov_b32 v105, 0
    v_mov_b32 v106, 0
    v_mov_b32 v107, 0
    v_lshrrev_b32 v41, 3, v1
    v_mul_u32_u24 v41, 4608, v41
    v_and_b32 v42, 7, v1
    v_lshl_add_u32 v243, v42, 3, v41
    v_cmp_gt_u32 vcc, 16, v1
    v_mov_b32 v43, 0x80000000
    s_nop 0
    v_cndmask_b32 v244, v43, v243, vcc
    v_and_b32 v41, 16, v1
    v_cmp_ne_u32 s[74:75], 0, v41
    s_mul_i32 s65, s56, 82944
    s_lshl_b32 s66, s71, 6
    s_add_u32 s65, s65, s66
    s_add_u32 s40, s65, 589824
    s_add_u32 s41, s40, 36864
    s_add_u32 s42, s40, 73728
    v_cndmask_b32 v246, 0, -1, vcc
    s_lshl_b32 s68, s56, 5
    s_add_u32 s68, s68, 73728
    v_add_u32 v130, s68, v59
    v_add_u32 v131, 32768, v130
    s_waitcnt vmcnt(18)
    s_barrier
    ds_read_b64_tr_b16 a[120:121], v130 offset:49152
    ds_read_b64_tr_b16 a[122:123], v130 offset:49664
    ds_read_b64_tr_b16 a[124:125], v130 offset:53248
    ds_read_b64_tr_b16 a[126:127], v130 offset:53760
    ds_read_b64_tr_b16 a[128:129], v130 offset:57344
    ds_read_b64_tr_b16 a[130:131], v130 offset:57856
    ds_read_b64_tr_b16 a[132:133], v131 offset:28672
    ds_read_b64_tr_b16 a[134:135], v131 offset:29184
    ds_read_b64_tr_b16 a[136:137], v131 offset:32768
    ds_read_b64_tr_b16 a[138:139], v131 offset:33280
    ds_read_b64_tr_b16 a[140:141], v131 offset:36864
    ds_read_b64_tr_b16 a[142:143], v131 offset:37376
    v_bfe_u32 v41, v1, 2, 2
    v_lshl_add_u32 v41, v58, 3, v41
    v_mul_u32_u24 v41, 1152, v41
    v_and_b32 v42, 3, v1
    v_lshl_add_u32 v128, v42, 3, v41
    s_mul_i32 s68, s56, 288
    v_add_u32 v128, s68, v128
    s_waitcnt vmcnt(0)
    s_barrier
    ds_read_b64_tr_b16 a[144:145], v128 offset:0
    ds_read_b64_tr_b16 a[146:147], v128 offset:4608
    ds_read_b64_tr_b16 a[148:149], v128 offset:36864
    ds_read_b64_tr_b16 a[150:151], v128 offset:41472
    ds_read_b64_tr_b16 a[152:153], v128 offset:32
    ds_read_b64_tr_b16 a[154:155], v128 offset:4640
    ds_read_b64_tr_b16 a[156:157], v128 offset:36896
    ds_read_b64_tr_b16 a[158:159], v128 offset:41504
    ds_read_b64_tr_b16 a[160:161], v128 offset:64
    ds_read_b64_tr_b16 a[162:163], v128 offset:4672
    ds_read_b64_tr_b16 a[164:165], v128 offset:36928
    ds_read_b64_tr_b16 a[166:167], v128 offset:41536
    ds_read_b64_tr_b16 a[168:169], v128 offset:96
    ds_read_b64_tr_b16 a[170:171], v128 offset:4704
    ds_read_b64_tr_b16 a[172:173], v128 offset:36960
    ds_read_b64_tr_b16 a[174:175], v128 offset:41568
    ds_read_b64_tr_b16 a[176:177], v128 offset:128
    ds_read_b64_tr_b16 a[178:179], v128 offset:4736
    ds_read_b64_tr_b16 a[180:181], v128 offset:36992
    ds_read_b64_tr_b16 a[182:183], v128 offset:41600
    ds_read_b64_tr_b16 a[184:185], v128 offset:160
    ds_read_b64_tr_b16 a[186:187], v128 offset:4768
    ds_read_b64_tr_b16 a[188:189], v128 offset:37024
    ds_read_b64_tr_b16 a[190:191], v128 offset:41632
    ds_read_b64_tr_b16 a[192:193], v128 offset:192
    ds_read_b64_tr_b16 a[194:195], v128 offset:4800
    ds_read_b64_tr_b16 a[196:197], v128 offset:37056
    ds_read_b64_tr_b16 a[198:199], v128 offset:41664
    ds_read_b64_tr_b16 a[200:201], v128 offset:224
    ds_read_b64_tr_b16 a[202:203], v128 offset:4832
    ds_read_b64_tr_b16 a[204:205], v128 offset:37088
    ds_read_b64_tr_b16 a[206:207], v128 offset:41696
    ds_read_b64_tr_b16 a[208:209], v128 offset:256
    ds_read_b64_tr_b16 a[210:211], v128 offset:4864
    ds_read_b64_tr_b16 a[212:213], v128 offset:37120
    ds_read_b64_tr_b16 a[214:215], v128 offset:41728
    v_cmp_ne_u32 vcc, 0, v246
    v_mov_b32 v43, 0x80000000
    s_cmp_ge_u32 s56, 2
    s_cbranch_scc1 L_ffn_b1
    v_lshlrev_b32 v41, 3, v1
    s_mul_i32 s65, s56, 1152
    v_add_u32 v44, 2048, v3
    v_cndmask_b32 v245, v43, v44, vcc
    v_cndmask_b32 v246, 0, -1, vcc
    v_lshlrev_b32 v41, 2, v1
    s_add_u32 s65, s65, 147456
    v_add_u32 v128, s65, v41
    v_add_u32 v42, 512, v128
    v_mov_b32 v44, 150016
    v_cndmask_b32 v129, v44, v42, vcc
    s_mul_i32 s65, s56, 2304
    s_add_u32 s66, s65, 524288
    s_add_u32 s65, s65, 158272
    v_add_u32 v130, s65, v3
    v_add_u32 v42, 2048, v130
    v_cndmask_b32 v131, v44, v42, vcc
    s_add_u32 s44, s66, 0
    s_add_u32 s45, s66, 4608
    s_add_u32 s46, s66, 9216
    s_add_u32 s47, s66, 13824
    s_add_u32 s48, s66, 18432
    s_add_u32 s49, s66, 23040
    s_add_u32 s50, s66, 27648
    s_add_u32 s51, s66, 32256
    s_waitcnt vmcnt(0)
    v_lshlrev_b32 v132, 16, v144
    v_and_b32 v133, s76, v144
    v_lshlrev_b32 v134, 16, v145
    v_and_b32 v135, s76, v145
    v_lshlrev_b32 v136, 16, v146
    v_and_b32 v137, s76, v146
    v_lshlrev_b32 v138, 16, v147
    v_and_b32 v139, s76, v147
    v_lshlrev_b32 v140, 16, v148
    v_and_b32 v141, s76, v148
    v_lshlrev_b32 v142, 16, v149
    v_and_b32 v143, s76, v149
    v_and_b32 v144, 15, v1
    v_lshlrev_b32 v144, 7, v144
    s_mov_b32 s62, 147456
L_fhint:
    buffer_load_dword v146, v144, s[36:39], s62 offen sc1
    s_waitcnt vmcnt(0)
    v_xor_b32 v146, v146, v56
    v_and_b32 v41, s79, v146
    v_cmp_ne_u32 vcc, 0, v41
    s_cbranch_vccz L_nh_4
    s_sub_u32 s73, s73, 1
    s_cbranch_scc0 L_fhint
    s_mov_b32 s73, 0
L_nh_4:
L_fagain:
    buffer_load_dwordx4 v[144:147], v3, s[36:39], s44 offen offset:0 sc1
    buffer_load_dwordx4 v[148:151], v3, s[36:39], s44 offen offset:1024 sc1
    buffer_load_dwordx4 v[152:155], v245, s[36:39], s44 offen sc1
    buffer_load_dwordx4 v[156:159], v3, s[36:39], s45 offen offset:0 sc1
    buffer_load_dwordx4 v[160:163], v3, s[36:39], s45 offen offset:1024 sc1
    buffer_load_dwordx4 v[164:167], v245, s[36:39], s45 offen sc1
    buffer_load_dwordx4 v[168:171], v3, s[36:39], s46 offen offset:0 sc1
    buffer_load_dwordx4 v[172:175], v3, s[36:39], s46 offen offset:1024 sc1
    buffer_load_dwordx4 v[176:179], v245, s[36:39], s46 offen sc1
    buffer_load_dwordx4 v[180:183], v3, s[36:39], s47 offen offset:0 sc1
    buffer_load_dwordx4 v[184:187], v3, s[36:39], s47 offen offset:1024 sc1
    buffer_load_dwordx4 v[188:191], v245, s[36:39], s47 offen sc1
    buffer_load_dwordx4 v[192:195], v3, s[36:39], s48 offen offset:0 sc1
    buffer_load_dwordx4 v[196:199], v3, s[36:39], s48 offen offset:1024 sc1
    buffer_load_dwordx4 v[200:203], v245, s[36:39], s48 offen sc1
    buffer_load_dwordx4 v[204:207], v3, s[36:39], s49 offen offset:0 sc1
    buffer_load_dwordx4 v[208:211], v3, s[36:39], s49 offen offset:1024 sc1
    buffer_load_dwordx4 v[212:215], v245, s[36:39], s49 offen sc1
    buffer_load_dwordx4 v[216:219], v3, s[36:39], s50 offen offset:0 sc1
    buffer_load_dwordx4 v[220:223], v3, s[36:39], s50 offen offset:1024 sc1
    buffer_load_dwordx4 v[224:227], v245, s[36:39], s50 offen sc1
    buffer_load_dwordx4 v[228:231], v3, s[36:39], s51 offen offset:0 sc1
    buffer_load_dwordx4 v[232:235], v3, s[36:39], s51 offen offset:1024 sc1
    buffer_load_dwordx4 v[236:239], v245, s[36:39], s51 offen sc1
    s_waitcnt vmcnt(21)
    v_xor_b32 v144, v144, v56
    v_xor_b32 v148, v148, v56
    v_xor_b32 v152, v152, v56
    v_or_b32 v41, v144, v148
    v_mov_b32 v42, v152
    v_pk_add_f32 v[144:145], v[132:133], v[144:145]
    v_pk_add_f32 v[146:147], v[134:135], v[146:147]
    v_pk_add_f32 v[148:149], v[136:137], v[148:149]
    v_pk_add_f32 v[150:151], v[138:139], v[150:151]
    v_pk_add_f32 v[152:153], v[140:141], v[152:153]
    v_pk_add_f32 v[154:155], v[142:143], v[154:155]
    s_waitcnt vmcnt(18)
    v_xor_b32 v156, v156, v56
    v_xor_b32 v160, v160, v56
    v_xor_b32 v164, v164, v56
    v_or3_b32 v41, v41, v156, v160
    v_or_b32 v42, v42, v164
    v_pk_add_f32 v[144:145], v[144:145], v[156:157]
    v_pk_add_f32 v[146:147], v[146:147], v[158:159]
    v_pk_add_f32 v[148:149], v[148:149], v[160:161]
    v_pk_add_f32 v[150:151], v[150:151], v[162:163]
    v_pk_add_f32 v[152:153], v[152:153], v[164:165]
    v_pk_add_f32 v[154:155], v[154:155], v[166:167]
    s_waitcnt vmcnt(15)
    v_xor_b32 v168, v168, v56
    v_xor_b32 v172, v172, v56
    v_xor_b32 v176, v176, v56
    v_or3_b32 v41, v41, v168, v172
    v_or_b32 v42, v42, v176
    v_pk_add_f32 v[144:145], v[144:145], v[168:169]
    v_pk_add_f32 v[146:147], v[146:147], v[170:171]
    v_pk_add_f32 v[148:149], v[148:149], v[172:173]
    v_pk_add_f32 v[150:151], v[150:151], v[174:175]
    v_pk_add_f32 v[152:153], v[152:153], v[176:177]
    v_pk_add_f32 v[154:155], v[154:155], v[178:179]
    s_waitcnt vmcnt(12)
    v_xor_b32 v180, v180, v56
    v_xor_b32 v184, v184, v56
    v_xor_b32 v188, v188, v56
    v_or3_b32 v41, v41, v180, v184
    v_or_b32 v42, v42, v188
    v_pk_add_f32 v[144:145], v[144:145], v[180:181]
    v_pk_add_f32 v[146:147], v[146:147], v[182:183]
    v_pk_add_f32 v[148:149], v[148:149], v[184:185]
    v_pk_add_f32 v[150:151], v[150:151], v[186:187]
    v_pk_add_f32 v[152:153], v[152:153], v[188:189]
    v_pk_add_f32 v[154:155], v[154:155], v[190:191]
    s_waitcnt vmcnt(9)
    v_xor_b32 v192, v192, v56
    v_xor_b32 v196, v196, v56
    v_xor_b32 v200, v200, v56
    v_or3_b32 v41, v41, v192, v196
    v_or_b32 v42, v42, v200
    v_pk_add_f32 v[144:145], v[144:145], v[192:193]
    v_pk_add_f32 v[146:147], v[146:147], v[194:195]
    v_pk_add_f32 v[148:149], v[148:149], v[196:197]
    v_pk_add_f32 v[150:151], v[150:151], v[198:199]
    v_pk_add_f32 v[152:153], v[152:153], v[200:201]
    v_pk_add_f32 v[154:155], v[154:155], v[202:203]
    s_waitcnt vmcnt(6)
    v_xor_b32 v204, v204, v56
    v_xor_b32 v208, v208, v56
    v_xor_b32 v212, v212, v56
    v_or3_b32 v41, v41, v204, v208
    v_or_b32 v42, v42, v212
    v_pk_add_f32 v[144:145], v[144:145], v[204:205]
    v_pk_add_f32 v[146:147], v[146:147], v[206:207]
    v_pk_add_f32 v[148:149], v[148:149], v[208:209]
    v_pk_add_f32 v[150:151], v[150:151], v[210:211]
    v_pk_add_f32 v[152:153], v[152:153], v[212:213]
    v_pk_add_f32 v[154:155], v[154:155], v[214:215]
    s_waitcnt vmcnt(3)
    v_xor_b32 v216, v216, v56
    v_xor_b32 v220, v220, v56
    v_xor_b32 v224, v224, v56
    v_or3_b32 v41, v41, v216, v220
    v_or_b32 v42, v42, v224
    v_pk_add_f32 v[144:145], v[144:145], v[216:217]
    v_pk_add_f32 v[146:147], v[146:147], v[218:219]
    v_pk_add_f32 v[148:149], v[148:149], v[220:221]
    v_pk_add_f32 v[150:151], v[150:151], v[222:223]
    v_pk_add_f32 v[152:153], v[152:153], v[224:225]
    v_pk_add_f32 v[154:155], v[154:155], v[226:227]
    s_waitcnt vmcnt(0)
    v_xor_b32 v228, v228, v56
    v_xor_b32 v232, v232, v56
    v_xor_b32 v236, v236, v56
    v_or3_b32 v41, v41, v228, v232
    v_or_b32 v42, v42, v236
    v_pk_add_f32 v[144:145], v[144:145], v[228:229]
    v_pk_add_f32 v[146:147], v[146:147], v[230:231]
    v_pk_add_f32 v[148:149], v[148:149], v[232:233]
    v_pk_add_f32 v[150:151], v[150:151], v[234:235]
    v_pk_add_f32 v[152:153], v[152:153], v[236:237]
    v_pk_add_f32 v[154:155], v[154:155], v[238:239]
    v_and_or_b32 v41, v42, v246, v41
    v_and_b32 v41, s79, v41
    v_cmp_ne_u32 vcc, 0, v41
    s_cbranch_vccz L_fd_5
    s_sub_u32 s73, s73, 1
    s_cbranch_scc0 L_fagain
    s_mov_b32 s73, 0
L_fd_5:
    v_pk_add_f32 v[156:157], v[144:145], v[146:147]
    v_pk_mul_f32 v[158:159], v[144:145], v[144:145]
    v_pk_fma_f32 v[158:159], v[146:147], v[146:147], v[158:159]
    v_pk_add_f32 v[156:157], v[156:157], v[148:149]
    v_pk_fma_f32 v[158:159], v[148:149], v[148:149], v[158:159]
    v_pk_add_f32 v[156:157], v[156:157], v[150:151]
    v_pk_fma_f32 v[158:159], v[150:151], v[150:151], v[158:159]
    v_pk_add_f32 v[156:157], v[156:157], v[152:153]
    v_pk_fma_f32 v[158:159], v[152:153], v[152:153], v[158:159]
    v_pk_add_f32 v[156:157], v[156:157], v[154:155]
    v_pk_fma_f32 v[158:159], v[154:155], v[154:155], v[158:159]
    v_add_f32 v156, v156, v157
    v_add_f32 v158, v158, v159
    s_nop 0
    v_add_f32_dpp v156, v156, v156 quad_perm:[1,0,3,2] row_mask:0xf bank_mask:0xf
    v_add_f32_dpp v158, v158, v158 quad_perm:[1,0,3,2] row_mask:0xf bank_mask:0xf
    s_nop 0
    v_add_f32_dpp v156, v156, v156 quad_perm:[2,3,0,1] row_mask:0xf bank_mask:0xf
    v_add_f32_dpp v158, v158, v158 quad_perm:[2,3,0,1] row_mask:0xf bank_mask:0xf
    s_nop 0
    v_add_f32_dpp v156, v156, v156 row_half_mirror row_mask:0xf bank_mask:0xf
    v_add_f32_dpp v158, v158, v158 row_half_mirror row_mask:0xf bank_mask:0xf
    s_nop 0
    v_add_f32_dpp v156, v156, v156 row_mirror row_mask:0xf bank_mask:0xf
    v_add_f32_dpp v158, v158, v158 row_mirror row_mask:0xf bank_mask:0xf
    s_nop 1
    v_permlane16_swap_b32 v156, v158
    v_add_f32 v156, v156, v158
    v_mov_b32 v158, v156
    s_nop 1
    v_permlane32_swap_b32 v156, v158
    v_add_f32 v156, v156, v158
    v_mul_f32 v156, 0x3ae38e39, v156
    v_mov_b32 v158, v156
    s_nop 1
    v_permlane16_swap_b32 v156, v158
    v_fma_f32 v158, -v156, v156, v158
    v_max_f32 v158, 0, v158
    v_add_f32 v158, 0x3727c5ac, v158
    v_rsq_f32 v158, v158
    s_nop 0
    v_mul_f32 v156, -v156, v158
    v_pk_fma_f32 v[160:161], v[144:145], v[158:159], v[156:157] op_sel_hi:[1,0,0]
    v_pk_fma_f32 v[162:163], v[146:147], v[158:159], v[156:157] op_sel_hi:[1,0,0]
    v_cvt_pk_bf16_f32 v160, v160, v161
    v_cvt_pk_bf16_f32 v161, v162, v163
    ds_write2_b32 v128, v160, v161 offset0:0 offset1:144
    v_pk_fma_f32 v[164:165], v[148:149], v[158:159], v[156:157] op_sel_hi:[1,0,0]
    v_pk_fma_f32 v[166:167], v[150:151], v[158:159], v[156:157] op_sel_hi:[1,0,0]
    v_cvt_pk_bf16_f32 v164, v164, v165
    v_cvt_pk_bf16_f32 v165, v166, v167
    ds_write2_b32 v128, v164, v165 offset0:64 offset1:208
    v_pk_fma_f32 v[168:169], v[152:153], v[158:159], v[156:157] op_sel_hi:[1,0,0]
    v_pk_fma_f32 v[170:171], v[154:155], v[158:159], v[156:157] op_sel_hi:[1,0,0]
    v_cvt_pk_bf16_f32 v168, v168, v169
    v_cvt_pk_bf16_f32 v169, v170, v171
    ds_write2_b32 v129, v168, v169 offset0:0 offset1:144
    s_waitcnt lgkmcnt(0)
    s_barrier
    ds_write_b128 v130, v[144:147]
    ds_write_b128 v130, v[148:151] offset:1024
    ds_write_b128 v131, v[152:155]
    s_branch L_ffn_b1d
L_ffn_b1:
    s_barrier
L_ffn_b1d:
    ds_read_b128 v[156:159], v240 offset:0
    ds_read_b128 v[160:163], v240 offset:64
    ds_read_b128 v[164:167], v240 offset:128
    ds_read_b128 v[168:171], v240 offset:192
    ds_read_b128 v[172:175], v240 offset:256
    ds_read_b128 v[176:179], v240 offset:320
    ds_read_b128 v[180:183], v240 offset:384
    ds_read_b128 v[184:187], v240 offset:448
    ds_read_b128 v[188:191], v240 offset:512
    s_waitcnt lgkmcnt(8)
    v_smfmac_f32_16x16x64_bf16 v[64:67], v[156:159], a[0:7], v55
    v_smfmac_f32_16x16x64_bf16 v[68:71], v[156:159], a[72:79], v55
    s_waitcnt lgkmcnt(7)
    v_smfmac_f32_16x16x64_bf16 v[64:67], v[160:163], a[8:15], v55
    v_smfmac_f32_16x16x64_bf16 v[68:71], v[160:163], a[80:87], v55
    s_waitcnt lgkmcnt(6)
    v_smfmac_f32_16x16x64_bf16 v[64:67], v[164:167], a[16:23], v55
    v_smfmac_f32_16x16x64_bf16 v[68:71], v[164:167], a[88:95], v55
    s_waitcnt lgkmcnt(5)
    v_smfmac_f32_16x16x64_bf16 v[64:67], v[168:171], a[24:31], v55
    v_smfmac_f32_16x16x64_bf16 v[68:71], v[168:171], a[96:103], v55
    s_waitcnt lgkmcnt(4)
    v_smfmac_f32_16x16x64_bf16 v[64:67], v[172:175], a[32:39], v55
    v_smfmac_f32_16x16x64_bf16 v[68:71], v[172:175], a[104:111], v55
    s_waitcnt lgkmcnt(3)
    v_smfmac_f32_16x16x64_bf16 v[64:67], v[176:179], a[40:47], v55
    v_smfmac_f32_16x16x64_bf16 v[68:71], v[176:179], a[112:119], v55
    s_waitcnt lgkmcnt(2)
    v_smfmac_f32_16x16x64_bf16 v[64:67], v[180:183], a[48:55], v55
    v_smfmac_f32_16x16x64_bf16 v[68:71], v[180:183], a[120:127], v55
    s_waitcnt lgkmcnt(1)
    v_smfmac_f32_16x16x64_bf16 v[64:67], v[184:187], a[56:63], v55
    v_smfmac_f32_16x16x64_bf16 v[68:71], v[184:187], a[128:135], v55
    s_waitcnt lgkmcnt(0)
    v_smfmac_f32_16x16x64_bf16 v[64:67], v[188:191], a[64:71], v55
    v_smfmac_f32_16x16x64_bf16 v[68:71], v[188:191], a[136:143], v55
    s_nop 6
    v_add_f32 v64, v64, v65
    v_add_f32 v65, v66, v67
    v_cndmask_b32 v41, v64, v65, s[74:75]
    v_mul_f32 v43, s1, v41
    v_exp_f32 v43, v43
    v_add_f32 v68, v68, v69
    v_add_f32 v69, v70, v71
    v_cndmask_b32 v42, v68, v69, s[74:75]
    v_add_f32 v43, 1.0, v43
    v_rcp_f32 v43, v43
    v_mul_f32 v41, v41, v42
    v_mul_f32 v41, v41, v43
    v_cvt_pk_bf16_f32 v41, v41, v41
    ds_write_b16 v242, v41
    s_waitcnt lgkmcnt(0)
    s_barrier
    ds_read_b128 v[156:159], v241
    s_waitcnt lgkmcnt(0)
    v_smfmac_f32_16x16x64_bf16 v[72:75], v[156:159], a[144:151], v55
    v_smfmac_f32_16x16x64_bf16 v[76:79], v[156:159], a[152:159], v55
    v_smfmac_f32_16x16x64_bf16 v[80:83], v[156:159], a[160:167], v55
    v_smfmac_f32_16x16x64_bf16 v[84:87], v[156:159], a[168:175], v55
    v_smfmac_f32_16x16x64_bf16 v[88:91], v[156:159], a[176:183], v55
    v_smfmac_f32_16x16x64_bf16 v[92:95], v[156:159], a[184:191], v55
    v_smfmac_f32_16x16x64_bf16 v[96:99], v[156:159], a[192:199], v55
    v_smfmac_f32_16x16x64_bf16 v[100:103], v[156:159], a[200:207], v55
    v_smfmac_f32_16x16x64_bf16 v[104:107], v[156:159], a[208:215], v55
    v_add_f32 v108, v72, v73
    v_add_f32 v109, v74, v75
    v_add_f32_dpp v108, v76, v77 quad_perm:[0,1,2,3] row_mask:0x2 bank_mask:0xf
    v_add_f32_dpp v109, v78, v79 quad_perm:[0,1,2,3] row_mask:0x2 bank_mask:0xf
    v_add_f32_dpp v108, v80, v81 quad_perm:[0,1,2,3] row_mask:0x4 bank_mask:0xf
    v_add_f32_dpp v109, v82, v83 quad_perm:[0,1,2,3] row_mask:0x4 bank_mask:0xf
    v_add_f32_dpp v108, v84, v85 quad_perm:[0,1,2,3] row_mask:0x8 bank_mask:0xf
    v_add_f32_dpp v109, v86, v87 quad_perm:[0,1,2,3] row_mask:0x8 bank_mask:0xf
    v_bfi_b32 v108, s79, v56, v108
    buffer_store_dwordx2 v[108:109], v243, s[36:39], s40 offen sc1
    v_add_f32 v110, v88, v89
    v_add_f32 v111, v90, v91
    v_add_f32_dpp v110, v92, v93 quad_perm:[0,1,2,3] row_mask:0x2 bank_mask:0xf
    v_add_f32_dpp v111, v94, v95 quad_perm:[0,1,2,3] row_mask:0x2 bank_mask:0xf
    v_add_f32_dpp v110, v96, v97 quad_perm:[0,1,2,3] row_mask:0x4 bank_mask:0xf
    v_add_f32_dpp v111, v98, v99 quad_perm:[0,1,2,3] row_mask:0x4 bank_mask:0xf
    v_add_f32_dpp v110, v100, v101 quad_perm:[0,1,2,3] row_mask:0x8 bank_mask:0xf
    v_add_f32_dpp v111, v102, v103 quad_perm:[0,1,2,3] row_mask:0x8 bank_mask:0xf
    v_bfi_b32 v110, s79, v56, v110
    buffer_store_dwordx2 v[110:111], v243, s[36:39], s41 offen sc1
    v_add_f32 v112, v104, v105
    v_add_f32 v113, v106, v107
    v_bfi_b32 v112, s79, v56, v112
    buffer_store_dwordx2 v[112:113], v244, s[36:39], s42 offen sc1
    s_cmp_lg_u32 s56, 0
    s_cbranch_scc1 L_finish
    s_mov_b32 s52, s22
    s_mov_b32 s53, s23
    s_mov_b32 s54, 2304
    s_mov_b32 s55, 0x20000
    v_cmp_gt_u32 vcc, 32, v1
    v_add_u32 v41, 4096, v3
    v_mov_b32 v43, 0x80000000
    v_cndmask_b32 v244, v43, v41, vcc
    v_cndmask_b32 v246, 0, -1, vcc
    s_mul_i32 s65, s71, 4608
    s_add_u32 s65, s65, 589824
    v_and_b32 v41, 1, v58
    v_mul_u32_u24 v41, 576, v41
    v_lshrrev_b32 v42, 1, v58
    v_add_u32 v41, v41, v42
    v_and_b32 v42, 3, v1
    v_lshl_add_u32 v41, v42, 1, v41
    s_lshl_b32 s66, s71, 3
    v_add_u32 v41, s66, v41
    v_lshlrev_b32 v240, 2, v41
    v_add_u32 v240, 158272, v240
    ds_read_b32 v241, v240
    v_lshlrev_b32 v41, 1, v41
    v_and_b32 v42, 12, v1
    v_cmp_eq_u32 vcc, 0, v42
    s_nop 1
    v_cndmask_b32 v243, v43, v41, vcc
    s_waitcnt vmcnt(2)
L_ragain:
    buffer_load_dwordx4 v[156:159], v3, s[36:39], s65 offen offset:0 sc1
    buffer_load_dwordx4 v[160:163], v3, s[36:39], s65 offen offset:1024 sc1
    buffer_load_dwordx4 v[164:167], v3, s[36:39], s65 offen offset:2048 sc1
    buffer_load_dwordx4 v[168:171], v3, s[36:39], s65 offen offset:3072 sc1
    buffer_load_dwordx4 v[172:175], v244, s[36:39], s65 offen sc1
    s_waitcnt vmcnt(0)
    v_xor_b32 v156, v156, v56
    v_xor_b32 v158, v158, v56
    v_xor_b32 v160, v160, v56
    v_xor_b32 v162, v162, v56
    v_xor_b32 v164, v164, v56
    v_xor_b32 v166, v166, v56
    v_xor_b32 v168, v168, v56
    v_xor_b32 v170, v170, v56
    v_xor_b32 v172, v172, v56
    v_xor_b32 v174, v174, v56
    v_or3_b32 v41, v156, v158, v160
    v_or3_b32 v41, v41, v162, v164
    v_or3_b32 v41, v41, v166, v168
    v_or_b32 v41, v41, v170
    v_or_b32 v42, v172, v174
    v_and_or_b32 v41, v42, v246, v41
    v_and_b32 v41, s79, v41
    v_cmp_ne_u32 vcc, 0, v41
    s_cbranch_vccz L_rd_6
    s_sub_u32 s73, s73, 1
    s_cbranch_scc0 L_ragain
    s_mov_b32 s73, 0
L_rd_6:
    v_pk_add_f32 v[156:157], v[156:157], v[160:161]
    v_pk_add_f32 v[164:165], v[164:165], v[168:169]
    v_pk_add_f32 v[158:159], v[158:159], v[162:163]
    v_pk_add_f32 v[166:167], v[166:167], v[170:171]
    v_pk_add_f32 v[156:157], v[156:157], v[172:173]
    v_pk_add_f32 v[158:159], v[158:159], v[174:175]
    v_pk_add_f32 v[156:157], v[156:157], v[164:165]
    v_pk_add_f32 v[158:159], v[158:159], v[166:167]
    s_nop 1
    v_permlane32_swap_b32 v156, v158
    v_permlane32_swap_b32 v157, v159
    v_pk_add_f32 v[156:157], v[156:157], v[158:159]
    s_nop 1
    v_permlane16_swap_b32 v156, v157
    v_add_f32 v156, v156, v157
    s_nop 1
    v_add_f32_dpp v156, v156, v156 row_ror:4 row_mask:0xf bank_mask:0xf
    s_nop 1
    v_add_f32_dpp v156, v156, v156 row_ror:8 row_mask:0xf bank_mask:0xf
    s_waitcnt lgkmcnt(0)
    v_add_f32 v156, v241, v156
    v_cvt_pk_bf16_f32 v156, v156, v156
    buffer_store_short v156, v243, s[52:55], 0 offen
    s_cmp_lg_u32 s71, 0
    s_cbranch_scc1 L_finish
    v_mov_b32 v44, 0x80000000
    v_cmp_eq_u32 vcc, 0, v1
    s_nop 1
    v_cndmask_b32 v41, v44, v1, vcc
    s_add_u32 s65, s89, 1
    v_mov_b32 v42, s65
    buffer_store_dword v42, v41, s[36:39], 0 offen offset:0 sc1
    s_branch L_finish
L_tail_plain:
    s_lshr_b32 s65, s59, 28
    s_add_u32 s65, s65, s56
    s_lshr_b32 s66, s59, 7
    s_sub_u32 s67, s65, 6
    s_cmp_ge_u32 s65, 6
    s_cselect_b32 s66, s66, s59
    s_cselect_b32 s65, s67, s65
    s_and_b32 s66, s66, 0x7f
    s_mov_b32 s44, s18
    s_mov_b32 s45, s19
    s_mov_b32 s46, 5308416
    s_mov_b32 s47, 0x20000
    v_lshrrev_b32 v41, 3, v1
    v_mul_u32_u24 v41, 9216, v41
    v_and_b32 v42, 7, v1
    v_lshl_add_u32 v41, v42, 4, v41
    s_mul_i32 s67, s65, 294912
    s_lshl_b32 s68, s66, 7
    s_add_u32 s67, s67, s68
    s_add_u32 s67, s67, 3538944
    s_cmp_lt_u32 s66, 72
    s_cselect_b32 s67, s67, 0x80000000
    buffer_load_dwordx4 v[128:131], v41, s[44:47], s67 offen
    s_add_u32 s67, s67, 73728
    buffer_load_dwordx4 v[132:135], v41, s[44:47], s67 offen
    s_add_u32 s67, s67, 73728
    buffer_load_dwordx4 v[136:139], v41, s[44:47], s67 offen
    s_add_u32 s67, s67, 73728
    buffer_load_dwordx4 v[140:143], v41, s[44:47], s67 offen
    s_mov_b32 s40, s20
    s_mov_b32 s41, s21
    s_mov_b32 s42, 5308416
    s_mov_b32 s43, 0x20000
    s_mul_i32 s66, s66, 73728
    s_mul_i32 s65, s65, 12288
    s_add_u32 s65, s65, s66
    buffer_load_dwordx4 v[64:67], v3, s[40:43], s65 offen offset:0
    buffer_load_dwordx4 v[68:71], v3, s[40:43], s65 offen offset:1024
    buffer_load_dwordx4 v[72:75], v3, s[40:43], s65 offen offset:2048
    buffer_load_dwordx4 v[76:79], v3, s[40:43], s65 offen offset:3072
    s_add_u32 s65, s65, 4096
    buffer_load_dwordx4 v[80:83], v3, s[40:43], s65 offen offset:0
    buffer_load_dwordx4 v[84:87], v3, s[40:43], s65 offen offset:1024
    buffer_load_dwordx4 v[88:91], v3, s[40:43], s65 offen offset:2048
    buffer_load_dwordx4 v[92:95], v3, s[40:43], s65 offen offset:3072
    s_add_u32 s65, s65, 4096
    buffer_load_dwordx4 v[96:99], v3, s[40:43], s65 offen offset:0
    buffer_load_dwordx4 v[100:103], v3, s[40:43], s65 offen offset:1024
    buffer_load_dwordx4 v[104:107], v3, s[40:43], s65 offen offset:2048
    buffer_load_dwordx4 v[108:111], v3, s[40:43], s65 offen offset:3072
    s_branch L_finish
L_tail_end:
L_stage_o:
    s_lshr_b32 s71, s59, 4
    s_and_b32 s72, s59, 15
    s_mov_b32 s40, s12
    s_mov_b32 s41, s13
    s_mov_b32 s42, 4718592
    s_mov_b32 s43, 0x20000
    v_lshrrev_b32 v41, 3, v1
    v_mul_u32_u24 v41, 1152, v41
    v_and_b32 v42, 7, v1
    v_lshl_add_u32 v129, v42, 4, v41
    s_lshl_b32 s67, s71, 9
    s_lshl_b32 s68, s56, 3
    s_add_u32 s67, s67, s68
    s_mul_i32 s67, s67, 1152
    s_lshl_b32 s68, s72, 7
    s_add_u32 s67, s67, s68
    s_lshl_b32 s69, s56, 10
    s_add_u32 s62, s67, 0
    s_add_u32 m0, s69, 0
    s_nop 0
    buffer_load_dwordx4 v129, s[40:43], s62 offen nt lds
    s_add_u32 s62, s67, 36864
    s_add_u32 m0, s69, 4096
    s_nop 0
    buffer_load_dwordx4 v129, s[40:43], s62 offen nt lds
    s_add_u32 s62, s67, 73728
    s_add_u32 m0, s69, 8192
    s_nop 0
    buffer_load_dwordx4 v129, s[40:43], s62 offen nt lds
    s_add_u32 s62, s67, 110592
    s_add_u32 m0, s69, 12288
    s_nop 0
    buffer_load_dwordx4 v129, s[40:43], s62 offen nt lds
    s_add_u32 s62, s67, 147456
    s_add_u32 m0, s69, 16384
    s_nop 0
    buffer_load_dwordx4 v129, s[40:43], s62 offen nt lds
    s_add_u32 s62, s67, 184320
    s_add_u32 m0, s69, 20480
    s_nop 0
    buffer_load_dwordx4 v129, s[40:43], s62 offen nt lds
    s_add_u32 s62, s67, 221184
    s_add_u32 m0, s69, 24576
    s_nop 0
    buffer_load_dwordx4 v129, s[40:43], s62 offen nt lds
    s_waitcnt vmcnt(15)
    s_add_u32 s62, s67, 258048
    s_add_u32 m0, s69, 28672
    s_nop 0
    buffer_load_dwordx4 v129, s[40:43], s62 offen nt lds
    s_waitcnt vmcnt(15)
    s_add_u32 s62, s67, 294912
    s_add_u32 m0, s69, 32768
    s_nop 0
    buffer_load_dwordx4 v129, s[40:43], s62 offen nt lds
    s_waitcnt vmcnt(15)
    s_add_u32 s62, s67, 331776
    s_add_u32 m0, s69, 36864
    s_nop 0
    buffer_load_dwordx4 v129, s[40:43], s62 offen nt lds
    s_waitcnt vmcnt(15)
    s_add_u32 s62, s67, 368640
    s_add_u32 m0, s69, 40960
    s_nop 0
    buffer_load_dwordx4 v129, s[40:43], s62 offen nt lds
    s_waitcnt vmcnt(15)
    s_add_u32 s62, s67, 405504
    s_add_u32 m0, s69, 45056
    s_nop 0
    buffer_load_dwordx4 v129, s[40:43], s62 offen nt lds
    s_waitcnt vmcnt(15)
    s_add_u32 s62, s67, 442368
    s_add_u32 m0, s69, 49152
    s_nop 0
    buffer_load_dwordx4 v129, s[40:43], s62 offen nt lds
    s_waitcnt vmcnt(15)
    s_add_u32 s62, s67, 479232
    s_add_u32 m0, s69, 53248
    s_nop 0
    buffer_load_dwordx4 v129, s[40:43], s62 offen nt lds
    s_waitcnt vmcnt(15)
    s_add_u32 s62, s67, 516096
    s_add_u32 m0, s69, 57344
    s_nop 0
    buffer_load_dwordx4 v129, s[40:43], s62 offen nt lds
    s_waitcnt vmcnt(15)
    s_add_u32 s62, s67, 552960
    s_add_u32 m0, s69, 61440
    s_nop 0
    buffer_load_dwordx4 v129, s[40:43], s62 offen nt lds
    s_add_u32 s62, s60, 32768
    buffer_load_dwordx4 v[96:99], v2, s[28:31], s62 offen offset:0 nt
    buffer_load_dwordx4 v[100:103], v2, s[28:31], s62 offen offset:1024 nt
    buffer_load_dwordx4 v[104:107], v2, s[28:31], s62 offen offset:2048 nt
    buffer_load_dwordx4 v[108:111], v2, s[28:31], s62 offen offset:3072 nt
    s_add_u32 s62, s60, 49152
    buffer_load_dwordx4 v[112:115], v2, s[28:31], s62 offen offset:0 nt
    buffer_load_dwordx4 v[116:119], v2, s[28:31], s62 offen offset:1024 nt
    buffer_load_dwordx4 v[120:123], v2, s[28:31], s62 offen offset:2048 nt
    buffer_load_dwordx4 v[124:127], v2, s[28:31], s62 offen offset:3072 nt
    v_bfe_u32 v41, v1, 3, 1
    v_lshlrev_b32 v41, 16, v41
    v_bfe_u32 v42, v1, 2, 1
    v_lshl_add_u32 v41, v42, 9, v41
    v_lshl_add_u32 v41, v58, 7, v41
    v_and_b32 v42, 3, v1
    v_lshl_add_u32 v128, v42, 5, v41
    s_lshl_b32 s65, s80, 10
    s_add_u32 s65, s65, 4096
    s_add_u32 s66, s65, 32768
    buffer_load_dwordx4 v[132:135], v128, s[36:39], s65 offen sc1
    buffer_load_dwordx4 v[136:139], v128, s[36:39], s65 offen offset:16 sc1
    buffer_load_dwordx4 v[140:143], v128, s[36:39], s66 offen sc1
    buffer_load_dwordx4 v[144:147], v128, s[36:39], s66 offen offset:16 sc1
    v_bfe_u32 v41, v1, 2, 2
    v_lshlrev_b32 v41, 2, v41
    v_add_u32 v41, v41, v58
    v_lshlrev_b32 v41, 1, v41
    v_mul_u32_u24 v41, 128, v41
    v_and_b32 v42, 3, v1
    v_lshl_add_u32 v129, v42, 3, v41
    s_lshl_b32 s68, s56, 5
    v_add_u32 v129, s68, v129
    s_waitcnt vmcnt(12)
    s_barrier
    ds_read_b64_tr_b16 a[0:1], v129 offset:0
    ds_read_b64_tr_b16 a[2:3], v129 offset:128
    ds_read_b64_tr_b16 a[4:5], v129 offset:4096
    ds_read_b64_tr_b16 a[6:7], v129 offset:4224
    ds_read_b64_tr_b16 a[8:9], v129 offset:8192
    ds_read_b64_tr_b16 a[10:11], v129 offset:8320
    ds_read_b64_tr_b16 a[12:13], v129 offset:12288
    ds_read_b64_tr_b16 a[14:15], v129 offset:12416
    ds_read_b64_tr_b16 a[16:17], v129 offset:16384
    ds_read_b64_tr_b16 a[18:19], v129 offset:16512
    ds_read_b64_tr_b16 a[20:21], v129 offset:20480
    ds_read_b64_tr_b16 a[22:23], v129 offset:20608
    ds_read_b64_tr_b16 a[24:25], v129 offset:24576
    ds_read_b64_tr_b16 a[26:27], v129 offset:24704
    ds_read_b64_tr_b16 a[28:29], v129 offset:28672
    ds_read_b64_tr_b16 a[30:31], v129 offset:28800
    ds_read_b64_tr_b16 a[32:33], v129 offset:32768
    ds_read_b64_tr_b16 a[34:35], v129 offset:32896
    ds_read_b64_tr_b16 a[36:37], v129 offset:36864
    ds_read_b64_tr_b16 a[38:39], v129 offset:36992
    ds_read_b64_tr_b16 a[40:41], v129 offset:40960
    ds_read_b64_tr_b16 a[42:43], v129 offset:41088
    ds_read_b64_tr_b16 a[44:45], v129 offset:45056
    ds_read_b64_tr_b16 a[46:47], v129 offset:45184
    ds_read_b64_tr_b16 a[48:49], v129 offset:49152
    ds_read_b64_tr_b16 a[50:51], v129 offset:49280
    ds_read_b64_tr_b16 a[52:53], v129 offset:53248
    ds_read_b64_tr_b16 a[54:55], v129 offset:53376
    ds_read_b64_tr_b16 a[56:57], v129 offset:57344
    ds_read_b64_tr_b16 a[58:59], v129 offset:57472
    ds_read_b64_tr_b16 a[60:61], v129 offset:61440
    ds_read_b64_tr_b16 a[62:63], v129 offset:61568
    s_branch L_staged
L_stage_ffn:
    s_mov_b32 s71, s59
    s_mov_b32 s40, s16
    s_mov_b32 s41, s17
    s_mov_b32 s42, 5308416
    s_mov_b32 s43, 0x20000
    s_mov_b32 s44, s18
    s_mov_b32 s45, s19
    s_mov_b32 s46, 5308416
    s_mov_b32 s47, 0x20000
    v_lshrrev_b32 v41, 3, v1
    v_mul_u32_u24 v41, 9216, v41
    v_and_b32 v42, 7, v1
    v_lshl_add_u32 v129, v42, 4, v41
    s_mul_i32 s67, s56, 73728
    s_lshl_b32 s68, s71, 7
    s_add_u32 s67, s67, s68
    s_lshl_b32 s69, s56, 10
    s_lshl_b32 s68, s56, 5
    v_add_u32 v130, s68, v59
    v_add_u32 v131, 73728, v130
    s_barrier
    v_add_u32 v148, 32768, v130
    v_add_u32 v149, 32768, v131
    s_add_u32 s62, s67, 0
    s_add_u32 m0, s69, 0
    s_nop 0
    buffer_load_dwordx4 v129, s[40:43], s62 offen nt lds
    s_add_u32 s62, s67, 294912
    s_add_u32 m0, s69, 4096
    s_nop 0
    buffer_load_dwordx4 v129, s[40:43], s62 offen nt lds
    s_add_u32 s62, s67, 589824
    s_add_u32 m0, s69, 8192
    s_nop 0
    buffer_load_dwordx4 v129, s[40:43], s62 offen nt lds
    s_add_u32 s62, s67, 884736
    s_add_u32 m0, s69, 12288
    s_nop 0
    buffer_load_dwordx4 v129, s[40:43], s62 offen nt lds
    s_add_u32 s62, s67, 1179648
    s_add_u32 m0, s69, 16384
    s_nop 0
    buffer_load_dwordx4 v129, s[40:43], s62 offen nt lds
    s_add_u32 s62, s67, 1474560
    s_add_u32 m0, s69, 20480
    s_nop 0
    buffer_load_dwordx4 v129, s[40:43], s62 offen nt lds
    s_add_u32 s62, s67, 1769472
    s_add_u32 m0, s69, 24576
    s_nop 0
    buffer_load_dwordx4 v129, s[40:43], s62 offen nt lds
    s_waitcnt vmcnt(15)
    s_add_u32 s62, s67, 2064384
    s_add_u32 m0, s69, 28672
    s_nop 0
    buffer_load_dwordx4 v129, s[40:43], s62 offen nt lds
    s_waitcnt vmcnt(15)
    s_add_u32 s62, s67, 2359296
    s_add_u32 m0, s69, 32768
    s_nop 0
    buffer_load_dwordx4 v129, s[40:43], s62 offen nt lds
    s_waitcnt vmcnt(15)
    s_add_u32 s62, s67, 2654208
    s_add_u32 m0, s69, 36864
    s_nop 0
    buffer_load_dwordx4 v129, s[40:43], s62 offen nt lds
    s_waitcnt vmcnt(15)
    s_add_u32 s62, s67, 2949120
    s_add_u32 m0, s69, 40960
    s_nop 0
    buffer_load_dwordx4 v129, s[40:43], s62 offen nt lds
    s_waitcnt vmcnt(15)
    s_add_u32 s62, s67, 3244032
    s_add_u32 m0, s69, 45056
    s_nop 0
    buffer_load_dwordx4 v129, s[40:43], s62 offen nt lds
    s_waitcnt vmcnt(15)
    s_add_u32 s62, s67, 3538944
    s_add_u32 m0, s69, 49152
    s_nop 0
    buffer_load_dwordx4 v129, s[40:43], s62 offen nt lds
    s_waitcnt vmcnt(15)
    s_add_u32 s62, s67, 3833856
    s_add_u32 m0, s69, 53248
    s_nop 0
    buffer_load_dwordx4 v129, s[40:43], s62 offen nt lds
    s_waitcnt vmcnt(15)
    s_add_u32 s62, s67, 4128768
    s_add_u32 m0, s69, 57344
    s_nop 0
    buffer_load_dwordx4 v129, s[40:43], s62 offen nt lds
    s_waitcnt vmcnt(15)
    s_add_u32 s62, s67, 4423680
    s_add_u32 m0, s69, 61440
    s_nop 0
    buffer_load_dwordx4 v129, s[40:43], s62 offen nt lds
    s_waitcnt vmcnt(15)
    s_add_u32 s62, s67, 4718592
    s_add_u32 m0, s69, 65536
    s_nop 0
    buffer_load_dwordx4 v129, s[40:43], s62 offen nt lds
    s_waitcnt vmcnt(15)
    s_add_u32 s62, s67, 5013504
    s_add_u32 m0, s69, 69632
    s_nop 0
    buffer_load_dwordx4 v129, s[40:43], s62 offen nt lds
    s_waitcnt vmcnt(15)
    s_add_u32 s62, s67, 0
    s_add_u32 m0, s69, 73728
    s_nop 0
    buffer_load_dwordx4 v129, s[44:47], s62 offen nt lds
    s_waitcnt vmcnt(15)
    s_add_u32 s62, s67, 294912
    s_add_u32 m0, s69, 77824
    s_nop 0
    buffer_load_dwordx4 v129, s[44:47], s62 offen nt lds
    s_waitcnt vmcnt(15)
    s_add_u32 s62, s67, 589824
    s_add_u32 m0, s69, 81920
    s_nop 0
    buffer_load_dwordx4 v129, s[44:47], s62 offen nt lds
    s_waitcnt vmcnt(15)
    s_add_u32 s62, s67, 884736
    s_add_u32 m0, s69, 86016
    s_nop 0
    buffer_load_dwordx4 v129, s[44:47], s62 offen nt lds
    s_waitcnt vmcnt(15)
    s_add_u32 s62, s67, 1179648
    s_add_u32 m0, s69, 90112
    s_nop 0
    buffer_load_dwordx4 v129, s[44:47], s62 offen nt lds
    s_waitcnt vmcnt(15)
    s_add_u32 s62, s67, 1474560
    s_add_u32 m0, s69, 94208
    s_nop 0
    buffer_load_dwordx4 v129, s[44:47], s62 offen nt lds
    s_waitcnt vmcnt(15)
    s_add_u32 s62, s67, 1769472
    s_add_u32 m0, s69, 98304
    s_nop 0
    buffer_load_dwordx4 v129, s[44:47], s62 offen nt lds
    s_waitcnt vmcnt(15)
    s_add_u32 s62, s67, 2064384
    s_add_u32 m0, s69, 102400
    s_nop 0
    buffer_load_dwordx4 v129, s[44:47], s62 offen nt lds
    s_waitcnt vmcnt(15)
    s_add_u32 s62, s67, 2359296
    s_add_u32 m0, s69, 106496
    s_nop 0
    buffer_load_dwordx4 v129, s[44:47], s62 offen nt lds
    s_waitcnt vmcnt(15)
    s_add_u32 s62, s67, 2654208
    s_add_u32 m0, s69, 110592
    s_nop 0
    buffer_load_dwordx4 v129, s[44:47], s62 offen nt lds
    s_waitcnt vmcnt(15)
    s_add_u32 s62, s67, 2949120
    s_add_u32 m0, s69, 114688
    s_nop 0
    buffer_load_dwordx4 v129, s[44:47], s62 offen nt lds
    s_waitcnt vmcnt(15)
    s_add_u32 s62, s67, 3244032
    s_add_u32 m0, s69, 118784
    s_nop 0
    buffer_load_dwordx4 v129, s[44:47], s62 offen nt lds
    s_waitcnt vmcnt(12)
    s_barrier
    ds_read_b64_tr_b16 a[0:1], v130 offset:0
    ds_read_b64_tr_b16 a[2:3], v130 offset:512
    ds_read_b64_tr_b16 a[4:5], v130 offset:4096
    ds_read_b64_tr_b16 a[6:7], v130 offset:4608
    ds_read_b64_tr_b16 a[8:9], v130 offset:8192
    ds_read_b64_tr_b16 a[10:11], v130 offset:8704
    ds_read_b64_tr_b16 a[12:13], v130 offset:12288
    ds_read_b64_tr_b16 a[14:15], v130 offset:12800
    ds_read_b64_tr_b16 a[16:17], v130 offset:16384
    ds_read_b64_tr_b16 a[18:19], v130 offset:16896
    ds_read_b64_tr_b16 a[20:21], v130 offset:20480
    ds_read_b64_tr_b16 a[22:23], v130 offset:20992
    ds_read_b64_tr_b16 a[24:25], v130 offset:24576
    ds_read_b64_tr_b16 a[26:27], v130 offset:25088
    ds_read_b64_tr_b16 a[28:29], v130 offset:28672
    ds_read_b64_tr_b16 a[30:31], v130 offset:29184
    ds_read_b64_tr_b16 a[32:33], v130 offset:32768
    ds_read_b64_tr_b16 a[34:35], v130 offset:33280
    ds_read_b64_tr_b16 a[36:37], v130 offset:36864
    ds_read_b64_tr_b16 a[38:39], v130 offset:37376
    ds_read_b64_tr_b16 a[40:41], v130 offset:40960
    ds_read_b64_tr_b16 a[42:43], v130 offset:41472
    ds_read_b64_tr_b16 a[44:45], v130 offset:45056
    ds_read_b64_tr_b16 a[46:47], v130 offset:45568
    ds_read_b64_tr_b16 a[48:49], v130 offset:49152
    ds_read_b64_tr_b16 a[50:51], v130 offset:49664
    ds_read_b64_tr_b16 a[52:53], v130 offset:53248
    ds_read_b64_tr_b16 a[54:55], v130 offset:53760
    ds_read_b64_tr_b16 a[56:57], v130 offset:57344
    ds_read_b64_tr_b16 a[58:59], v130 offset:57856
    ds_read_b64_tr_b16 a[60:61], v148 offset:28672
    ds_read_b64_tr_b16 a[62:63], v148 offset:29184
    ds_read_b64_tr_b16 a[64:65], v148 offset:32768
    ds_read_b64_tr_b16 a[66:67], v148 offset:33280
    ds_read_b64_tr_b16 a[68:69], v148 offset:36864
    ds_read_b64_tr_b16 a[70:71], v148 offset:37376
    s_add_u32 s62, s60, 32768
    buffer_load_dwordx4 v[96:99], v2, s[28:31], s62 offen offset:0 nt
    buffer_load_dwordx4 v[100:103], v2, s[28:31], s62 offen offset:1024 nt
    buffer_load_dwordx4 v[104:107], v2, s[28:31], s62 offen offset:2048 nt
    buffer_load_dwordx4 v[108:111], v2, s[28:31], s62 offen offset:3072 nt
    s_add_u32 s62, s60, 49152
    buffer_load_dwordx4 v[112:115], v2, s[28:31], s62 offen offset:0 nt
    buffer_load_dwordx4 v[116:119], v2, s[28:31], s62 offen offset:1024 nt
    buffer_load_dwordx4 v[120:123], v2, s[28:31], s62 offen offset:2048 nt
    buffer_load_dwordx4 v[124:127], v2, s[28:31], s62 offen offset:3072 nt
    v_bfe_u32 v41, v1, 3, 1
    v_lshlrev_b32 v41, 16, v41
    v_bfe_u32 v42, v1, 2, 1
    v_lshl_add_u32 v41, v42, 9, v41
    v_lshl_add_u32 v41, v58, 7, v41
    v_and_b32 v42, 3, v1
    v_lshl_add_u32 v128, v42, 5, v41
    s_lshl_b32 s65, s80, 10
    s_add_u32 s65, s65, 4096
    s_add_u32 s66, s65, 32768
    buffer_load_dwordx4 v[132:135], v128, s[36:39], s65 offen sc1
    buffer_load_dwordx4 v[136:139], v128, s[36:39], s65 offen offset:16 sc1
    buffer_load_dwordx4 v[140:143], v128, s[36:39], s66 offen sc1
    buffer_load_dwordx4 v[144:147], v128, s[36:39], s66 offen offset:16 sc1
    s_waitcnt vmcnt(12)
    s_barrier
    ds_read_b64_tr_b16 a[72:73], v131 offset:0
    ds_read_b64_tr_b16 a[74:75], v131 offset:512
    ds_read_b64_tr_b16 a[76:77], v131 offset:4096
    ds_read_b64_tr_b16 a[78:79], v131 offset:4608
    ds_read_b64_tr_b16 a[80:81], v131 offset:8192
    ds_read_b64_tr_b16 a[82:83], v131 offset:8704
    ds_read_b64_tr_b16 a[84:85], v131 offset:12288
    ds_read_b64_tr_b16 a[86:87], v131 offset:12800
    ds_read_b64_tr_b16 a[88:89], v131 offset:16384
    ds_read_b64_tr_b16 a[90:91], v131 offset:16896
    ds_read_b64_tr_b16 a[92:93], v131 offset:20480
    ds_read_b64_tr_b16 a[94:95], v131 offset:20992
    ds_read_b64_tr_b16 a[96:97], v131 offset:24576
    ds_read_b64_tr_b16 a[98:99], v131 offset:25088
    ds_read_b64_tr_b16 a[100:101], v131 offset:28672
    ds_read_b64_tr_b16 a[102:103], v131 offset:29184
    ds_read_b64_tr_b16 a[104:105], v131 offset:32768
    ds_read_b64_tr_b16 a[106:107], v131 offset:33280
    ds_read_b64_tr_b16 a[108:109], v131 offset:36864
    ds_read_b64_tr_b16 a[110:111], v131 offset:37376
    ds_read_b64_tr_b16 a[112:113], v131 offset:40960
    ds_read_b64_tr_b16 a[114:115], v131 offset:41472
    ds_read_b64_tr_b16 a[116:117], v131 offset:45056
    ds_read_b64_tr_b16 a[118:119], v131 offset:45568
    s_branch L_staged
L_finish:
L_end:
    s_endpgm
.p2align 4
.type L_table,@object
L_table:
.long 0x2031800, 0x0
.long 0x2031840, 0x1
.long 0x1031880, 0x20
.long 0x10318c0, 0x30
.long 0x1031900, 0x40
.long 0x31940, 0xa340885
.long 0x31980, 0xc380a09
.long 0x319c0, 0xe3c0a8a
.long 0x31800, 0x200300
.long 0x31840, 0x2240381
.long 0x2031880, 0x2
.long 0x20318c0, 0x3
.long 0x31900, 0x8300804
.long 0x1031940, 0x50
.long 0x1031980, 0x60
.long 0x10319c0, 0x70
.long 0x1031800, 0x0
.long 0x1031840, 0x10
.long 0x31880, 0x4280402
.long 0x318c0, 0x62c0703
.long 0x2031900, 0x4
.long 0x2031940, 0x5
.long 0x1031980, 0x61
.long 0x319c0, 0x4e3c0a8a
.long 0x2031800, 0x6
.long 0x2031840, 0x7
.long 0x2031880, 0x8
.long 0x318c0, 0x462c0703
.long 0x31900, 0x48300804
.long 0x31940, 0x4a340885
.long 0x31980, 0x4c380a09
.long 0x319c0, 0x2e5c4d15
.long 0x1031840, 0x1
.long 0x1031880, 0x11
.long 0x10318c0, 0x21
.long 0x31900, 0x264c478e
.long 0x31940, 0x28504910
.long 0x31980, 0x2a544991
.long 0x20319c0, 0x9
.long 0x2031800, 0xa
.long 0x2031840, 0xb
.long 0x2031880, 0xc
.long 0x318c0, 0x44280402
.long 0x1031900, 0x31
.long 0x1031940, 0x41
.long 0x1031980, 0x51
.long 0x319c0, 0x2c584c94
.long 0x31800, 0xe7c901a
.long 0x31840, 0x40200300
.long 0x31880, 0x42240381
.long 0x20318c0, 0xd
.long 0x2031900, 0xe
.long 0x1031940, 0x42
.long 0x1031980, 0x52
.long 0x319c0, 0xc788f99
.long 0x1031800, 0x71
.long 0x31840, 0x20404586
.long 0x31880, 0x22444607
.long 0x318c0, 0x24484688
.long 0x2031900, 0xf
.long 0x2031940, 0x10
.long 0x2031980, 0x11
.long 0x319c0, 0x4c788f99
.long 0x31800, 0x4e7c901a
.long 0x1031880, 0x2
.long 0x318c0, 0x2648b8c
.long 0x31900, 0x4688d8d
.long 0x31940, 0x66c8e0f
.long 0x2031980, 0x12
.long 0x20319c0, 0x13
.long 0x1031800, 0x62
.long 0x1031840, 0x72
.long 0x31880, 0x608b0b
.long 0x10318c0, 0x12
.long 0x1031900, 0x22
.long 0x1031940, 0x32
.long 0x31980, 0x8708e92
.long 0x319c0, 0xa748f13
.long 0x2031800, 0x14
.long 0x2031840, 0x15
.long 0x2031880, 0x16
.long 0x20318c0, 0x17
.long 0x1031900, 0x23
.long 0x1031940, 0x33
.long 0x1031980, 0x43
.long 0x319c0, 0x4a748f13
.long 0x31800, 0x2c98d61f
.long 0x31840, 0x2e9cd720
.long 0x2031880, 0x18
.long 0x318c0, 0x42648b8c
.long 0x31900, 0x44688d8d
.long 0x31940, 0x466c8e0f
.long 0x31980, 0x48708e92
.long 0x319c0, 0x2a94d49e
.long 0x2031800, 0x19
.long 0x2031840, 0x1a
.long 0x318c0, 0x40608b0b
.long 0x31900, 0x2284d097
.long 0x2031940, 0x1b
.long 0x2031980, 0x1c
.long 0x319c0, 0x2890d41d
.long 0x1031800, 0x53
.long 0x1031840, 0x63
.long 0x1031880, 0x73
.long 0x10318c0, 0x3
.long 0x1031900, 0x13
.long 0x31940, 0x2488d11b
.long 0x31980, 0x268cd19c
.long 0x20319c0, 0x1d
.long 0x2031800, 0x1e
.long 0x1031840, 0x64
.long 0x31880, 0xebd1aae
.long 0x10318c0, 0x4
.long 0x1031900, 0x14
.long 0x1031940, 0x24
.long 0x31980, 0x6ad13a3
.long 0x319c0, 0x8b11528
.long 0x31800, 0xab515a9
.long 0x2031840, 0x1f
.long 0x2031880, 0x20
.long 0x318c0, 0x2080cc16
.long 0x2031900, 0x21
.long 0x2031940, 0x22
.long 0x2031980, 0x23
.long 0x319c0, 0x48b11528
.long 0x31800, 0x4ab515a9
.long 0x31840, 0xcb916ac
.long 0x31880, 0x4ebd1aae
.long 0x2031900, 0x24
.long 0x2031940, 0x25
.long 0x31980, 0x4a91322
.long 0x10319c0, 0x34
.long 0x1031800, 0x44
.long 0x1031840, 0x54
.long 0x31880, 0x4cb916ac
.long 0x318c0, 0x2edd5cb5
.long 0x31900, 0xa11218
.long 0x31940, 0x2a512a1
.long 0x2031980, 0x26
.long 0x20319c0, 0x27
.long 0x1031800, 0x45
.long 0x1031840, 0x55
.long 0x31880, 0x2cd95c2d
.long 0x10318c0, 0x74
.long 0x1031900, 0x5
.long 0x31940, 0x42a512a1
.long 0x31980, 0x44a91322
.long 0x319c0, 0x46ad13a3
.long 0x2031800, 0x28
.long 0x2031840, 0x29
.long 0x1031880, 0x65
.long 0x10318c0, 0x75
.long 0x31900, 0x40a11218
.long 0x31940, 0x22c55825
.long 0x31980, 0x24c958a6
.long 0x319c0, 0x26cd5927
.long 0x2031800, 0x2a
.long 0x2031840, 0x2b
.long 0x2031880, 0x2c
.long 0x318c0, 0xefda239
.long 0x31940, 0x20c157a4
.long 0x1031980, 0x15
.long 0x10319c0, 0x25
.long 0x1031800, 0x35
.long 0x31840, 0x28d15b2a
.long 0x31880, 0x2ad55bab
.long 0x20318c0, 0x2d
.long 0x2031900, 0x2e
.long 0x2031940, 0x2f
.long 0x2031980, 0x30
.long 0x10319c0, 0x26
.long 0x1031800, 0x36
.long 0x1031840, 0x46
.long 0x31880, 0xaf5a137
.long 0x318c0, 0xcf9a1b8
.long 0x31900, 0x4efda239
.long 0x31940, 0xe199af
.long 0x31980, 0x2e59a30
.long 0x20319c0, 0x31
.long 0x2031800, 0x32
.long 0x31840, 0x8f19f36
.long 0x1031880, 0x56
.long 0x10318c0, 0x66
.long 0x1031900, 0x76
.long 0x2031940, 0x33
.long 0x2031980, 0x34
.long 0x319c0, 0x4e99e31
.long 0x31800, 0x6ed9eb2
.long 0x31840, 0x48f19f36
.long 0x31880, 0x4af5a137
.long 0x318c0, 0x4cf9a1b8
.long 0x2031900, 0x35
.long 0x1031980, 0x6
.long 0x10319c0, 0x16
.long 0x31800, 0x44e99e31
.long 0x31840, 0x46ed9eb2
.long 0x2031880, 0x36
.long 0x20318c0, 0x37
.long 0x1031900, 0x67
.long 0x31940, 0x2f1de3c4
.long 0x1031980, 0x7
.long 0x10319c0, 0x17
.long 0x1031800, 0x27
.long 0x31840, 0x270de03d
.long 0x31880, 0x2911e0be
.long 0x318c0, 0x2b15e2c2
.long 0x2031900, 0x38
.long 0x2031940, 0x39
.long 0x2031980, 0x3a
.long 0x20319c0, 0x3b
.long 0x31800, 0x2509dfbc
.long 0x1031840, 0x37
.long 0x1031880, 0x47
.long 0x10318c0, 0x57
.long 0x31900, 0x2d19e343
.long 0x31940, 0xffe3fc7
.long 0x31980, 0x40e199af
.long 0x319c0, 0x42e59a30
.long 0x2031800, 0x3c
.long 0x2031840, 0x3d
.long 0x2031880, 0x3e
.long 0x318c0, 0xff63fc5
.long 0x31900, 0xffa3fc6
.long 0x31940, 0x4ffe3fc7
.long 0x319c0, 0x2101dd33
.long 0x31800, 0x2305ddb4
.long 0x2031840, 0x3f
.long 0x2031880, 0x40
.long 0x10318c0, 0x48
.long 0x1031900, 0x58
.long 0x31940, 0x4ffa3fc6
.long 0x1031980, 0x77
.long 0x10319c0, 0x8
.long 0x31800, 0xfe63fbb
.long 0x31840, 0xfea3fbf
.long 0x31880, 0xfee3fc0
.long 0x20318c0, 0x41
.long 0x2031900, 0x42
.long 0x1031940, 0x68
.long 0x1031980, 0x78
.long 0x319c0, 0xfe23fba
.long 0x1031800, 0x18
.long 0x1031840, 0x28
.long 0x1031880, 0x38
.long 0x318c0, 0xff23fc1
.long 0x31900, 0x4ff63fc5
.long 0x2031940, 0x43
.long 0x2031980, 0x44
.long 0x319c0, 0x4fe23fba
.long 0x31800, 0x4fe63fbb
.long 0x31840, 0x4fea3fbf
.long 0x31880, 0x4fee3fc0
.long 0x318c0, 0x4ff23fc1
.long 0x2031900, 0x45
.long 0x2031940, 0x46
.long 0x2031980, 0x47
.size L_table, 2048
.section .rodata,"a"
.p2align 6
.amdhsa_kernel sequential_preLN__gqa_block_cached__glu_gated_swiglu__decode_kernel
  .amdhsa_next_free_vgpr 472
  .amdhsa_next_free_sgpr 102
  .amdhsa_accum_offset 256
  .amdhsa_group_segment_fixed_size 0
  .amdhsa_kernarg_size 96
  .amdhsa_user_sgpr_count 2
  .amdhsa_user_sgpr_kernarg_segment_ptr 1
  .amdhsa_system_sgpr_workgroup_id_x 1
  .amdhsa_float_denorm_mode_32 3
.end_amdhsa_kernel
```
